```python
import torch

def _softmax(x, axis=-1):
    return torch.softmax(x, dim=axis)
def _gelu(x):
    return torch.nn.functional.gelu(x, approximate="tanh")
def _silu(x):
    return torch.nn.functional.silu(x)
def _sigmoid(x):
    return torch.sigmoid(x)
def _layernorm(x, axis=-1, eps=1e-5):
    m = x.mean(dim=axis, keepdim=True)
    v = x.var(dim=axis, keepdim=True, unbiased=False)
    return (x - m) / torch.sqrt(v + eps)
def _scatter_add(tgt, idx, src, axis=0):
    return tgt.clone().index_add_(axis, idx, src)
def _segment_sum(src, seg, n):
    out = torch.zeros((n,) + src.shape[1:], dtype=src.dtype)
    return out.index_add_(0, seg, src)
def _pad(x, pw):
    flat = tuple(v for pair in reversed(pw) for v in pair)
    return torch.nn.functional.pad(x, flat)

kernel_name = 'standalone__gqa_block_cached__decode'

def setup_inputs():

    _w = (lambda a: (lambda t: t.to(torch.bfloat16) if t.is_floating_point() else t)(torch.as_tensor(a)))
    B, Sq, D = 8, 1, 512
    Hq, Hkv, Sk, Dh = 32, 8, 4096, 128
    assert Hq % Hkv == 0, (Hq, Hkv)
    return {
        "x": _w((lambda *s: torch.randn(*s, dtype=torch.bfloat16) * 0.8)(B, Sq, D)),
        "k_cache": _w((lambda *s: torch.randn(*s, dtype=torch.bfloat16) * 0.8)(B, Hkv, Sk, Dh)),
        "v_cache": _w((lambda *s: torch.randn(*s, dtype=torch.bfloat16) * 0.05)(B, Hkv, Sk, Dh)),
        "wq": _w((lambda *s: torch.randn(*s, dtype=torch.bfloat16) * 0.8)(D, Hq * Dh) * (D ** -0.5)),
        "wo": _w((lambda *s: torch.randn(*s, dtype=torch.bfloat16) * 0.05)(Hq * Dh, D) * ((Hq * Dh) ** -0.5)),
    }

def reference(x, k_cache, v_cache, wq, wo):
    B, Sq, D = x.shape
    Hq, Dh = 32, 128
    Hkv = k_cache.shape[1]
    rep = Hq // Hkv
    q = (lambda x, *d: x.permute(*d))((x @ wq).reshape(B, Sq, Hq, Dh), 0, 2, 1, 3)
    k = (lambda x, n, axis: torch.repeat_interleave(x, n, dim=axis))(k_cache, rep, axis=1)
    v = (lambda x, n, axis: torch.repeat_interleave(x, n, dim=axis))(v_cache, rep, axis=1)
    scores = torch.einsum("bhqd,bhkd->bhqk", q, k) * (Dh ** -0.5)
    p = _softmax(scores, axis=-1)
    o = torch.einsum("bhqk,bhkd->bhqd", p, v)
    return (lambda x, *d: x.permute(*d))(o, 0, 2, 1, 3).reshape(B, Sq, Hq * Dh) @ wo
```

```asm
; @launch grid=(256,1,1) block=(512,1,1) lds=57344
.amdgcn_target "amdgcn-amd-amdhsa--gfx950"
.text
.globl standalone__gqa_block_cached__decode_kernel
.p2align 8
.type standalone__gqa_block_cached__decode_kernel,@function
standalone__gqa_block_cached__decode_kernel:
    s_cmp_ge_u32 s2, 256
    s_cbranch_scc1 L_end
    s_load_dwordx16 s[4:19], s[0:1], 0
    v_lshrrev_b32 v6, 6, v0
    v_and_b32 v1, 63, v0
    v_readfirstlane_b32 s3, v6
    s_and_b32 s54, s2, 7
    s_lshr_b32 s53, s2, 3
    s_lshr_b32 s52, s53, 2
    s_and_b32 s55, s53, 3
    s_lshr_b32 s35, s53, 3
    s_and_b32 s34, s53, 7
    s_lshl_b32 s33, s54, 2
    s_add_u32 s33, s33, s35
    s_getreg_b32 s32, hwreg(HW_REG_XCC_ID)
    s_and_b32 s32, s32, 15
    v_mov_b32 v10, 34816
    v_mov_b32 v12, 0
    v_mov_b32 v13, 0
    v_mov_b32 v14, 0
    v_mov_b32 v15, 0
    ds_write_b128 v10, v[12:15]
    ds_write_b128 v10, v[12:15] offset:16
    v_and_b32 v6, 15, v1
    v_lshrrev_b32 v7, 4, v1
    v_lshrrev_b32 v8, 2, v6
    v_and_b32 v9, 3, v6
    v_lshlrev_b32 v2, 8, v8
    v_lshl_add_u32 v2, v7, 6, v2
    v_lshl_add_u32 v2, v9, 4, v2
    v_lshlrev_b32 v3, 4, v1
    v_lshrrev_b32 v10, 3, v1
    v_lshlrev_b32 v10, 13, v10
    v_and_b32 v11, 7, v1
    v_lshl_add_u32 v10, v11, 4, v10
    v_lshlrev_b32 v12, 10, v6
    v_lshl_add_u32 v12, v7, 4, v12
    v_mov_b32 v13, 4198400
    s_lshl_b32 s58, s52, 23
    s_lshl_b32 s60, s54, 20
    s_add_u32 s58, s58, s60
    s_lshl_b32 s60, s55, 18
    s_add_u32 s58, s58, s60
    s_lshl_b32 s60, s3, 15
    s_add_u32 s58, s58, s60
    s_mul_i32 s56, s54, 19
    s_mul_i32 s59, s53, 13
    s_add_u32 s56, s56, s59
    s_mul_i32 s59, s3, 19
    s_add_u32 s56, s56, s59
    s_and_b32 s56, s56, 31
    s_lshl_b32 s56, s56, 10
    s_lshl_b32 s100, s54, 10
    s_lshl_b32 s60, s52, 7
    s_add_u32 s100, s100, s60
    s_lshl_b32 s60, s55, 20
    s_add_u32 s100, s100, s60
    s_lshl_b32 s60, s3, 18
    s_add_u32 s100, s100, s60
    s_waitcnt lgkmcnt(0)
    s_add_u32 s20, s6, s58
    s_addc_u32 s21, s7, 0
    s_and_b32 s21, s21, 0xffff
    s_mov_b32 s22, 0x8000
    s_mov_b32 s23, 0x20000
    s_mov_b32 s44, s10
    s_and_b32 s45, s11, 0xffff
    s_mov_b32 s46, 0x400000
    s_mov_b32 s47, 0x20000
    s_mov_b32 s40, s4
    s_and_b32 s41, s5, 0xffff
    s_mov_b32 s42, 0x2000
    s_mov_b32 s43, 0x20000
    s_mov_b32 s28, s18
    s_and_b32 s29, s19, 0xffff
    s_mov_b32 s30, 0x500000
    s_mov_b32 s31, 0x20000
    s_cmp_ge_u32 s3, 4
    s_cbranch_scc1 L_noq1
    s_lshl_b32 s60, s3, 12
    s_add_u32 m0, s60, 0
    s_add_u32 s59, s100, 0
    buffer_load_dwordx4 v10, s[44:47], s59 offen nt lds
    s_add_u32 m0, s60, 1024
    s_add_u32 s59, s100, 65536
    buffer_load_dwordx4 v10, s[44:47], s59 offen nt lds
    s_add_u32 m0, s60, 2048
    s_add_u32 s59, s100, 131072
    buffer_load_dwordx4 v10, s[44:47], s59 offen nt lds
    s_add_u32 m0, s60, 3072
    s_add_u32 s59, s100, 196608
    buffer_load_dwordx4 v10, s[44:47], s59 offen nt lds
    s_lshl_b32 s59, s55, 8
    s_lshl_b32 s60, s3, 6
    s_add_u32 s59, s59, s60
    buffer_load_dwordx4 v[64:67], v12, s[40:43], s59 offen
L_noq1:
    buffer_load_dwordx2 v[126:127], v13, s[28:31], 0 offen sc1
    s_xor_b32 s60, s56, 0
    buffer_load_dwordx4 v[128:131], v2, s[20:23], s60 offen nt
    s_xor_b32 s60, s56, 4096
    buffer_load_dwordx4 v[132:135], v2, s[20:23], s60 offen nt
    s_barrier
    s_xor_b32 s60, s56, 8192
    buffer_load_dwordx4 v[136:139], v2, s[20:23], s60 offen nt
    s_xor_b32 s60, s56, 12288
    buffer_load_dwordx4 v[140:143], v2, s[20:23], s60 offen nt
    s_xor_b32 s60, s56, 16384
    buffer_load_dwordx4 v[144:147], v2, s[20:23], s60 offen nt
    s_xor_b32 s60, s56, 20480
    buffer_load_dwordx4 v[148:151], v2, s[20:23], s60 offen nt
    s_xor_b32 s60, s56, 24576
    buffer_load_dwordx4 v[152:155], v2, s[20:23], s60 offen nt
    s_xor_b32 s60, s56, 28672
    buffer_load_dwordx4 v[156:159], v2, s[20:23], s60 offen nt
    s_add_u32 s24, s8, s58
    s_addc_u32 s25, s9, 0
    s_and_b32 s25, s25, 0xffff
    s_mov_b32 s26, 0x8000
    s_mov_b32 s27, 0x20000
    s_mov_b32 s36, s14
    s_and_b32 s37, s15, 0xffff
    s_mov_b32 s38, 0x2000
    s_mov_b32 s39, 0x20000
    s_mov_b32 s48, s12
    s_and_b32 s49, s13, 0xffff
    s_mov_b32 s50, 0x400000
    s_mov_b32 s51, 0x20000
    s_mov_b32 s57, 0x3e0293ee
    v_and_b32 v10, 1, v1
    v_lshlrev_b32 v10, 4, v10
    v_mov_b32 v11, 0xffff
    v_lshlrev_b32 v11, v10, v11
    v_bfe_i32 v10, v1, 1, 1
    v_and_b32 v5, v11, v10
    v_xor_b32 v4, v11, v5
    v_mov_b32 v96, 0
    v_mov_b32 v97, 0
    v_mov_b32 v100, 0
    v_mov_b32 v101, 0
    v_mov_b32 v104, 0
    v_mov_b32 v105, 0
    s_cmp_ge_u32 s3, 4
    s_cbranch_scc1 L_young
    v_lshlrev_b32 v11, 3, v7
    v_add_u32 v11, v11, v8
    v_lshlrev_b32 v11, 7, v11
    v_lshl_add_u32 v11, v9, 3, v11
    s_lshl_b32 s60, s3, 12
    v_add_u32 v11, s60, v11
    v_add_u32 v12, s60, v3
    v_mov_b32 v13, 34820
    v_mov_b32 v14, 1
    s_waitcnt vmcnt(8)
    ds_read_b64_tr_b16 v[80:81], v11 offset:0
    ds_read_b64_tr_b16 v[82:83], v11 offset:512
    ds_read_b64_tr_b16 v[84:85], v11 offset:32
    ds_read_b64_tr_b16 v[86:87], v11 offset:544
    ds_read_b64_tr_b16 v[88:89], v11 offset:64
    ds_read_b64_tr_b16 v[90:91], v11 offset:576
    ds_read_b64_tr_b16 v[92:93], v11 offset:96
    ds_read_b64_tr_b16 v[94:95], v11 offset:608
    v_readfirstlane_b32 s96, v126
    v_readfirstlane_b32 s97, v127
    s_nop 0
    s_add_u32 s98, s96, 1
    s_and_b32 s99, s98, 0xff
    s_waitcnt lgkmcnt(0)
    v_mfma_f32_16x16x32_bf16 v[32:35], v[80:83], v[64:67], 0
    v_mfma_f32_16x16x32_bf16 v[36:39], v[84:87], v[64:67], 0
    v_mfma_f32_16x16x32_bf16 v[40:43], v[88:91], v[64:67], 0
    v_mfma_f32_16x16x32_bf16 v[44:47], v[92:95], v[64:67], 0
    s_nop 7
    ds_write_b128 v12, v[32:35] offset:40960
    ds_write_b128 v12, v[36:39] offset:41984
    ds_write_b128 v12, v[40:43] offset:43008
    ds_write_b128 v12, v[44:47] offset:44032
    s_waitcnt lgkmcnt(0)
    s_mov_b64 exec, 1
    ds_add_rtn_u32 v10, v13, v14
    s_waitcnt lgkmcnt(0)
    s_mov_b64 exec, -1
    v_readfirstlane_b32 s58, v10
    s_nop 0
    s_cmp_lg_u32 s58, 3
    s_cbranch_scc1 L_rest
    ds_read_b128 v[32:35], v3 offset:40960
    ds_read_b128 v[36:39], v3 offset:41984
    ds_read_b128 v[40:43], v3 offset:43008
    ds_read_b128 v[44:47], v3 offset:44032
    ds_read_b128 v[48:51], v3 offset:45056
    ds_read_b128 v[52:55], v3 offset:46080
    ds_read_b128 v[56:59], v3 offset:47104
    ds_read_b128 v[60:63], v3 offset:48128
    ds_read_b128 v[64:67], v3 offset:49152
    ds_read_b128 v[68:71], v3 offset:50176
    ds_read_b128 v[72:75], v3 offset:51200
    ds_read_b128 v[76:79], v3 offset:52224
    ds_read_b128 v[80:83], v3 offset:53248
    ds_read_b128 v[84:87], v3 offset:54272
    ds_read_b128 v[88:91], v3 offset:55296
    ds_read_b128 v[92:95], v3 offset:56320
    s_waitcnt lgkmcnt(0)
    v_add_f32 v32, v32, v64
    v_add_f32 v33, v33, v65
    v_add_f32 v34, v34, v66
    v_add_f32 v35, v35, v67
    v_add_f32 v36, v36, v68
    v_add_f32 v37, v37, v69
    v_add_f32 v38, v38, v70
    v_add_f32 v39, v39, v71
    v_add_f32 v40, v40, v72
    v_add_f32 v41, v41, v73
    v_add_f32 v42, v42, v74
    v_add_f32 v43, v43, v75
    v_add_f32 v44, v44, v76
    v_add_f32 v45, v45, v77
    v_add_f32 v46, v46, v78
    v_add_f32 v47, v47, v79
    v_add_f32 v48, v48, v80
    v_add_f32 v49, v49, v81
    v_add_f32 v50, v50, v82
    v_add_f32 v51, v51, v83
    v_add_f32 v52, v52, v84
    v_add_f32 v53, v53, v85
    v_add_f32 v54, v54, v86
    v_add_f32 v55, v55, v87
    v_add_f32 v56, v56, v88
    v_add_f32 v57, v57, v89
    v_add_f32 v58, v58, v90
    v_add_f32 v59, v59, v91
    v_add_f32 v60, v60, v92
    v_add_f32 v61, v61, v93
    v_add_f32 v62, v62, v94
    v_add_f32 v63, v63, v95
    v_add_f32 v32, v32, v48
    v_add_f32 v33, v33, v49
    v_add_f32 v34, v34, v50
    v_add_f32 v35, v35, v51
    v_add_f32 v36, v36, v52
    v_add_f32 v37, v37, v53
    v_add_f32 v38, v38, v54
    v_add_f32 v39, v39, v55
    v_add_f32 v40, v40, v56
    v_add_f32 v41, v41, v57
    v_add_f32 v42, v42, v58
    v_add_f32 v43, v43, v59
    v_add_f32 v44, v44, v60
    v_add_f32 v45, v45, v61
    v_add_f32 v46, v46, v62
    v_add_f32 v47, v47, v63
    ds_write_b128 v3, v[32:35] offset:40960
    ds_write_b128 v3, v[36:39] offset:41984
    ds_write_b128 v3, v[40:43] offset:43008
    ds_write_b128 v3, v[44:47] offset:44032
    v_and_b32 v12, 7, v6
    v_lshlrev_b32 v12, 16, v12
    v_lshl_add_u32 v12, v7, 4, v12
    v_lshrrev_b32 v13, 3, v6
    v_lshl_add_u32 v12, v13, 6, v12
    s_lshl_b32 s59, s54, 13
    s_lshl_b32 s60, s55, 11
    s_add_u32 s59, s59, s60
    s_lshl_b32 s60, s52, 8
    s_add_u32 s59, s59, s60
    s_lshl_b32 s58, s32, 8
    s_or_b32 s58, s58, s99
    v_mov_b32 v13, 0xfffff000
    v_mov_b32_dpp v32, v36 row_shr:8 row_mask:0xf bank_mask:0xc
    v_mov_b32_dpp v33, v37 row_shr:8 row_mask:0xf bank_mask:0xc
    v_mov_b32_dpp v34, v38 row_shr:8 row_mask:0xf bank_mask:0xc
    v_mov_b32_dpp v35, v39 row_shr:8 row_mask:0xf bank_mask:0xc
    v_mov_b32_dpp v40, v44 row_shr:8 row_mask:0xf bank_mask:0xc
    v_mov_b32_dpp v41, v45 row_shr:8 row_mask:0xf bank_mask:0xc
    v_mov_b32_dpp v42, v46 row_shr:8 row_mask:0xf bank_mask:0xc
    v_mov_b32_dpp v43, v47 row_shr:8 row_mask:0xf bank_mask:0xc
    v_add_u32 v64, 0x800, v32
    v_and_or_b32 v64, v64, v13, s58
    v_add_u32 v65, 0x800, v33
    v_and_or_b32 v65, v65, v13, s58
    v_add_u32 v66, 0x800, v34
    v_and_or_b32 v66, v66, v13, s58
    v_add_u32 v67, 0x800, v35
    v_and_or_b32 v67, v67, v13, s58
    v_add_u32 v68, 0x800, v40
    v_and_or_b32 v68, v68, v13, s58
    v_add_u32 v69, 0x800, v41
    v_and_or_b32 v69, v69, v13, s58
    v_add_u32 v70, 0x800, v42
    v_and_or_b32 v70, v70, v13, s58
    v_add_u32 v71, 0x800, v43
    v_and_or_b32 v71, v71, v13, s58
    buffer_store_dwordx4 v[64:67], v12, s[28:31], s59 offen offset:0
    buffer_store_dwordx4 v[68:71], v12, s[28:31], s59 offen offset:128
    v_mov_b32 v13, 34828
    v_mov_b32 v14, 1
    s_waitcnt lgkmcnt(0)
    ds_write_b32 v13, v14
    s_branch L_rest
L_young:
    s_cmp_lg_u32 s3, 5
    s_cbranch_scc1 L_ncpf
    s_getpc_b64 s[58:59]
L_pc:
    s_sub_u32 s58, s58, L_pc-standalone__gqa_block_cached__decode_kernel
    s_subb_u32 s59, s59, 0
    s_and_b32 s60, s53, 3
    s_lshl_b32 s60, s60, 12
    v_lshlrev_b32 v11, 6, v1
    v_add_u32 v11, s60, v11
    v_min_u32 v11, L_end-standalone__gqa_block_cached__decode_kernel, v11
    global_load_dword v106, v11, s[58:59]
L_ncpf:
L_rest:
    s_xor_b32 s60, s56, 1024
    buffer_load_dwordx4 v[160:163], v2, s[20:23], s60 offen nt
    s_xor_b32 s60, s56, 5120
    buffer_load_dwordx4 v[164:167], v2, s[20:23], s60 offen nt
    s_xor_b32 s60, s56, 9216
    buffer_load_dwordx4 v[168:171], v2, s[20:23], s60 offen nt
    s_xor_b32 s60, s56, 13312
    buffer_load_dwordx4 v[172:175], v2, s[20:23], s60 offen nt
    s_xor_b32 s60, s56, 17408
    buffer_load_dwordx4 v[176:179], v2, s[20:23], s60 offen nt
    s_xor_b32 s60, s56, 21504
    buffer_load_dwordx4 v[180:183], v2, s[20:23], s60 offen nt
    s_xor_b32 s60, s56, 25600
    buffer_load_dwordx4 v[184:187], v2, s[20:23], s60 offen nt
    s_xor_b32 s60, s56, 29696
    buffer_load_dwordx4 v[188:191], v2, s[20:23], s60 offen nt
    s_xor_b32 s60, s56, 2048
    buffer_load_dwordx4 v[192:195], v2, s[20:23], s60 offen nt
    s_xor_b32 s60, s56, 6144
    buffer_load_dwordx4 v[196:199], v2, s[20:23], s60 offen nt
    s_xor_b32 s60, s56, 10240
    buffer_load_dwordx4 v[200:203], v2, s[20:23], s60 offen nt
    s_xor_b32 s60, s56, 14336
    buffer_load_dwordx4 v[204:207], v2, s[20:23], s60 offen nt
    s_xor_b32 s60, s56, 18432
    buffer_load_dwordx4 v[208:211], v2, s[20:23], s60 offen nt
    s_xor_b32 s60, s56, 22528
    buffer_load_dwordx4 v[212:215], v2, s[20:23], s60 offen nt
    s_xor_b32 s60, s56, 26624
    buffer_load_dwordx4 v[216:219], v2, s[20:23], s60 offen nt
    s_xor_b32 s60, s56, 30720
    buffer_load_dwordx4 v[220:223], v2, s[20:23], s60 offen nt
    s_xor_b32 s60, s56, 3072
    buffer_load_dwordx4 v[224:227], v2, s[20:23], s60 offen nt
    s_xor_b32 s60, s56, 7168
    buffer_load_dwordx4 v[228:231], v2, s[20:23], s60 offen nt
    s_xor_b32 s60, s56, 11264
    buffer_load_dwordx4 v[232:235], v2, s[20:23], s60 offen nt
    s_xor_b32 s60, s56, 15360
    buffer_load_dwordx4 v[236:239], v2, s[20:23], s60 offen nt
    s_xor_b32 s60, s56, 19456
    buffer_load_dwordx4 v[240:243], v2, s[20:23], s60 offen nt
    s_xor_b32 s60, s56, 23552
    buffer_load_dwordx4 v[244:247], v2, s[20:23], s60 offen nt
    s_xor_b32 s60, s56, 27648
    buffer_load_dwordx4 v[248:251], v2, s[20:23], s60 offen nt
    s_xor_b32 s60, s56, 31744
    buffer_load_dwordx4 v[252:255], v2, s[20:23], s60 offen nt
    s_waitcnt vmcnt(32)
    v_readfirstlane_b32 s96, v126
    v_readfirstlane_b32 s97, v127
    s_nop 0
    s_add_u32 s98, s96, 1
    s_and_b32 s99, s98, 0xff
    v_mov_b32 v10, 34816
    s_cmp_eq_u32 s3, 0
    s_cbranch_scc1 L_qwave
L_wflag:
    ds_read_b32 v12, v10
    s_waitcnt lgkmcnt(0)
    v_readfirstlane_b32 s58, v12
    s_nop 0
    s_cmp_lg_u32 s58, 0
    s_cbranch_scc1 L_getq
    s_sleep 2
    s_branch L_wflag
L_qwave:
    s_mov_b32 s61, 20000
    s_mov_b32 s88, 0
    s_mov_b32 s89, 0
    s_lshl_b32 s90, s52, 16
    s_lshl_b32 s60, s54, 13
    s_add_u32 s90, s90, s60
L_pollq:
    s_and_b32 s101, s89, s88
    s_lshl_b32 s58, s101, 20
    s_add_u32 s58, s58, s90
    buffer_load_dwordx4 v[32:35], v3, s[28:31], s58 offen offset:0 sc1
    buffer_load_dwordx4 v[36:39], v3, s[28:31], s58 offen offset:1024 sc1
    buffer_load_dwordx4 v[40:43], v3, s[28:31], s58 offen offset:2048 sc1
    buffer_load_dwordx4 v[44:47], v3, s[28:31], s58 offen offset:3072 sc1
    s_add_u32 s58, s58, 4096
    buffer_load_dwordx4 v[48:51], v3, s[28:31], s58 offen offset:0 sc1
    buffer_load_dwordx4 v[52:55], v3, s[28:31], s58 offen offset:1024 sc1
    buffer_load_dwordx4 v[56:59], v3, s[28:31], s58 offen offset:2048 sc1
    buffer_load_dwordx4 v[60:63], v3, s[28:31], s58 offen offset:3072 sc1
    s_lshl_b32 s58, s32, 8
    s_or_b32 s58, s58, s99
    s_and_b32 s59, s98, 0xfff
    s_cmp_lg_u32 s101, 0
    s_cselect_b32 s58, s59, s58
    s_cselect_b32 s59, 0xf00, 0
    s_or_b32 s59, s59, 0xff
    s_waitcnt vmcnt(0)
    v_xor_b32 v12, s58, v32
    v_xor_b32 v14, s58, v33
    v_or_b32 v12, v12, v14
    v_xor_b32 v14, s58, v34
    v_or_b32 v12, v12, v14
    v_xor_b32 v14, s58, v35
    v_or_b32 v12, v12, v14
    v_xor_b32 v14, s58, v36
    v_or_b32 v12, v12, v14
    v_xor_b32 v14, s58, v37
    v_or_b32 v12, v12, v14
    v_xor_b32 v14, s58, v38
    v_or_b32 v12, v12, v14
    v_xor_b32 v14, s58, v39
    v_or_b32 v12, v12, v14
    v_xor_b32 v14, s58, v40
    v_or_b32 v12, v12, v14
    v_xor_b32 v14, s58, v41
    v_or_b32 v12, v12, v14
    v_xor_b32 v14, s58, v42
    v_or_b32 v12, v12, v14
    v_xor_b32 v14, s58, v43
    v_or_b32 v12, v12, v14
    v_xor_b32 v14, s58, v44
    v_or_b32 v12, v12, v14
    v_xor_b32 v14, s58, v45
    v_or_b32 v12, v12, v14
    v_xor_b32 v14, s58, v46
    v_or_b32 v12, v12, v14
    v_xor_b32 v14, s58, v47
    v_or_b32 v12, v12, v14
    v_xor_b32 v14, s58, v48
    v_or_b32 v12, v12, v14
    v_xor_b32 v14, s58, v49
    v_or_b32 v12, v12, v14
    v_xor_b32 v14, s58, v50
    v_or_b32 v12, v12, v14
    v_xor_b32 v14, s58, v51
    v_or_b32 v12, v12, v14
    v_xor_b32 v14, s58, v52
    v_or_b32 v12, v12, v14
    v_xor_b32 v14, s58, v53
    v_or_b32 v12, v12, v14
    v_xor_b32 v14, s58, v54
    v_or_b32 v12, v12, v14
    v_xor_b32 v14, s58, v55
    v_or_b32 v12, v12, v14
    v_xor_b32 v14, s58, v56
    v_or_b32 v12, v12, v14
    v_xor_b32 v14, s58, v57
    v_or_b32 v12, v12, v14
    v_xor_b32 v14, s58, v58
    v_or_b32 v12, v12, v14
    v_xor_b32 v14, s58, v59
    v_or_b32 v12, v12, v14
    v_xor_b32 v14, s58, v60
    v_or_b32 v12, v12, v14
    v_xor_b32 v14, s58, v61
    v_or_b32 v12, v12, v14
    v_xor_b32 v14, s58, v62
    v_or_b32 v12, v12, v14
    v_xor_b32 v14, s58, v63
    v_or_b32 v12, v12, v14
    v_bfe_u32 v13, v12, 8, 4
    v_and_b32 v12, s59, v12
    v_cmp_ne_u32 vcc, 0, v12
    s_nop 1
    s_cbranch_vccz L_qvalid
    s_add_u32 s89, s89, 1
    s_cmp_lt_u32 s89, 64
    s_cbranch_scc1 L_qnext
    s_cmp_lg_u32 s88, 0
    s_cbranch_scc1 L_qnext
    s_mov_b32 s88, 1
    s_mov_b32 s62, 0
L_qfb:
L_wqp:
    ds_read_b32 v12, v10 offset:12
    s_waitcnt lgkmcnt(0)
    v_readfirstlane_b32 s58, v12
    s_nop 0
    s_cmp_lg_u32 s58, 0
    s_cbranch_scc1 L_wqp2
    s_sleep 2
    s_branch L_wqp
L_wqp2:
    ds_read_b128 v[32:35], v3 offset:40960
    ds_read_b128 v[36:39], v3 offset:41984
    ds_read_b128 v[40:43], v3 offset:43008
    ds_read_b128 v[44:47], v3 offset:44032
    s_waitcnt lgkmcnt(0)
    v_and_b32 v12, 7, v6
    v_lshlrev_b32 v12, 16, v12
    v_lshl_add_u32 v12, v7, 4, v12
    v_lshrrev_b32 v13, 3, v6
    v_lshl_add_u32 v12, v13, 6, v12
    s_lshl_b32 s59, s54, 13
    s_lshl_b32 s60, s55, 11
    s_add_u32 s59, s59, s60
    s_lshl_b32 s60, s52, 8
    s_add_u32 s59, s59, s60
    s_add_u32 s59, s59, 0x100000
    s_and_b32 s58, s98, 0xfff
    v_mov_b32 v13, 0xfffff000
    v_mov_b32_dpp v32, v36 row_shr:8 row_mask:0xf bank_mask:0xc
    v_mov_b32_dpp v33, v37 row_shr:8 row_mask:0xf bank_mask:0xc
    v_mov_b32_dpp v34, v38 row_shr:8 row_mask:0xf bank_mask:0xc
    v_mov_b32_dpp v35, v39 row_shr:8 row_mask:0xf bank_mask:0xc
    v_mov_b32_dpp v40, v44 row_shr:8 row_mask:0xf bank_mask:0xc
    v_mov_b32_dpp v41, v45 row_shr:8 row_mask:0xf bank_mask:0xc
    v_mov_b32_dpp v42, v46 row_shr:8 row_mask:0xf bank_mask:0xc
    v_mov_b32_dpp v43, v47 row_shr:8 row_mask:0xf bank_mask:0xc
    v_add_u32 v64, 0x800, v32
    v_and_or_b32 v64, v64, v13, s58
    v_add_u32 v65, 0x800, v33
    v_and_or_b32 v65, v65, v13, s58
    v_add_u32 v66, 0x800, v34
    v_and_or_b32 v66, v66, v13, s58
    v_add_u32 v67, 0x800, v35
    v_and_or_b32 v67, v67, v13, s58
    v_add_u32 v68, 0x800, v40
    v_and_or_b32 v68, v68, v13, s58
    v_add_u32 v69, 0x800, v41
    v_and_or_b32 v69, v69, v13, s58
    v_add_u32 v70, 0x800, v42
    v_and_or_b32 v70, v70, v13, s58
    v_add_u32 v71, 0x800, v43
    v_and_or_b32 v71, v71, v13, s58
    buffer_store_dwordx4 v[64:67], v12, s[28:31], s59 offen offset:0 sc1
    buffer_store_dwordx4 v[68:71], v12, s[28:31], s59 offen offset:128 sc1
    s_nop 1
L_qnext:
    s_sleep 1
    s_sub_u32 s61, s61, 1
    s_cmp_lg_u32 s61, 0
    s_cbranch_scc1 L_pollq
    s_branch L_got
L_qvalid:
    s_cmp_lg_u32 s101, 0
    s_cbranch_scc1 L_got
    v_cmp_ne_u32 vcc, 0, v13
    s_nop 1
    s_cbranch_vccz L_gotl
    s_cmp_lg_u32 s88, 0
    s_cbranch_scc1 L_got
    s_mov_b32 s88, 1
    s_branch L_qfb
L_gotl:
    v_mov_b32 v12, 1
    ds_write_b32 v10, v12 offset:8
L_got:
    v_lshlrev_b32 v13, 3, v1
    v_add_u32 v11, 32768, v13
    v_mov_b32 v13, 0xfffff000
    v_and_b32 v32, v32, v13
    v_and_b32 v33, v33, v13
    v_and_b32 v34, v34, v13
    v_and_b32 v35, v35, v13
    v_and_b32 v36, v36, v13
    v_and_b32 v37, v37, v13
    v_and_b32 v38, v38, v13
    v_and_b32 v39, v39, v13
    v_and_b32 v40, v40, v13
    v_and_b32 v41, v41, v13
    v_and_b32 v42, v42, v13
    v_and_b32 v43, v43, v13
    v_and_b32 v44, v44, v13
    v_and_b32 v45, v45, v13
    v_and_b32 v46, v46, v13
    v_and_b32 v47, v47, v13
    v_and_b32 v48, v48, v13
    v_and_b32 v49, v49, v13
    v_and_b32 v50, v50, v13
    v_and_b32 v51, v51, v13
    v_and_b32 v52, v52, v13
    v_and_b32 v53, v53, v13
    v_and_b32 v54, v54, v13
    v_and_b32 v55, v55, v13
    v_and_b32 v56, v56, v13
    v_and_b32 v57, v57, v13
    v_and_b32 v58, v58, v13
    v_and_b32 v59, v59, v13
    v_and_b32 v60, v60, v13
    v_and_b32 v61, v61, v13
    v_and_b32 v62, v62, v13
    v_and_b32 v63, v63, v13
    v_add_f32 v32, v32, v48
    v_add_f32 v33, v33, v49
    v_add_f32 v34, v34, v50
    v_add_f32 v35, v35, v51
    v_add_f32 v36, v36, v52
    v_add_f32 v37, v37, v53
    v_add_f32 v38, v38, v54
    v_add_f32 v39, v39, v55
    v_add_f32 v40, v40, v56
    v_add_f32 v41, v41, v57
    v_add_f32 v42, v42, v58
    v_add_f32 v43, v43, v59
    v_add_f32 v44, v44, v60
    v_add_f32 v45, v45, v61
    v_add_f32 v46, v46, v62
    v_add_f32 v47, v47, v63
    v_add_f32 v32, v32, v40
    v_add_f32 v33, v33, v41
    v_add_f32 v34, v34, v42
    v_add_f32 v35, v35, v43
    v_add_f32 v36, v36, v44
    v_add_f32 v37, v37, v45
    v_add_f32 v38, v38, v46
    v_add_f32 v39, v39, v47
    v_cvt_pk_bf16_f32 v32, v32, v33
    v_cvt_pk_bf16_f32 v33, v34, v35
    ds_write_b64 v11, v[32:33] offset:0
    v_cvt_pk_bf16_f32 v36, v36, v37
    v_cvt_pk_bf16_f32 v37, v38, v39
    ds_write_b64 v11, v[36:37] offset:512
    v_mov_b32 v12, 1
    s_waitcnt lgkmcnt(0)
    ds_write_b32 v10, v12
L_getq:
    v_lshlrev_b32 v10, 8, v8
    v_lshl_add_u32 v10, v7, 6, v10
    ds_read_b128 v[16:19], v10 offset:32768
    ds_read_b128 v[20:23], v10 offset:32784
    ds_read_b128 v[24:27], v10 offset:32800
    ds_read_b128 v[28:31], v10 offset:32816
    s_waitcnt lgkmcnt(0)
    s_waitcnt vmcnt(31)
    v_mfma_f32_16x16x32_bf16 v[32:35], v[128:131], v[16:19], 0
    v_mfma_f32_16x16x32_bf16 v[36:39], v[128:131], v[20:23], 0
    v_mfma_f32_16x16x32_bf16 v[40:43], v[128:131], v[24:27], 0
    v_mfma_f32_16x16x32_bf16 v[44:47], v[128:131], v[28:31], 0
    s_xor_b32 s60, s56, 0
    buffer_load_dwordx4 v[128:131], v3, s[24:27], s60 offen nt
    s_waitcnt vmcnt(31)
    v_mfma_f32_16x16x32_bf16 v[48:51], v[132:135], v[16:19], 0
    v_mfma_f32_16x16x32_bf16 v[52:55], v[132:135], v[20:23], 0
    v_mfma_f32_16x16x32_bf16 v[56:59], v[132:135], v[24:27], 0
    v_mfma_f32_16x16x32_bf16 v[60:63], v[132:135], v[28:31], 0
    s_xor_b32 s60, s56, 4096
    buffer_load_dwordx4 v[132:135], v3, s[24:27], s60 offen nt
    v_add_f32 v64, v32, v37
    v_add_f32 v116, v42, v47
    v_add_f32 v64, v64, v116
    s_waitcnt vmcnt(31)
    v_mfma_f32_16x16x32_bf16 v[32:35], v[136:139], v[16:19], 0
    v_mfma_f32_16x16x32_bf16 v[36:39], v[136:139], v[20:23], 0
    v_mfma_f32_16x16x32_bf16 v[40:43], v[136:139], v[24:27], 0
    v_mfma_f32_16x16x32_bf16 v[44:47], v[136:139], v[28:31], 0
    s_xor_b32 s60, s56, 8192
    buffer_load_dwordx4 v[136:139], v3, s[24:27], s60 offen nt
    v_add_f32 v65, v48, v53
    v_add_f32 v116, v58, v63
    v_add_f32 v65, v65, v116
    s_waitcnt vmcnt(31)
    v_mfma_f32_16x16x32_bf16 v[48:51], v[140:143], v[16:19], 0
    v_mfma_f32_16x16x32_bf16 v[52:55], v[140:143], v[20:23], 0
    v_mfma_f32_16x16x32_bf16 v[56:59], v[140:143], v[24:27], 0
    v_mfma_f32_16x16x32_bf16 v[60:63], v[140:143], v[28:31], 0
    s_xor_b32 s60, s56, 12288
    buffer_load_dwordx4 v[140:143], v3, s[24:27], s60 offen nt
    v_add_f32 v66, v32, v37
    v_add_f32 v116, v42, v47
    v_add_f32 v66, v66, v116
    s_waitcnt vmcnt(31)
    v_mfma_f32_16x16x32_bf16 v[32:35], v[144:147], v[16:19], 0
    v_mfma_f32_16x16x32_bf16 v[36:39], v[144:147], v[20:23], 0
    v_mfma_f32_16x16x32_bf16 v[40:43], v[144:147], v[24:27], 0
    v_mfma_f32_16x16x32_bf16 v[44:47], v[144:147], v[28:31], 0
    s_xor_b32 s60, s56, 16384
    buffer_load_dwordx4 v[144:147], v3, s[24:27], s60 offen nt
    v_add_f32 v67, v48, v53
    v_add_f32 v116, v58, v63
    v_add_f32 v67, v67, v116
    s_waitcnt vmcnt(31)
    v_mfma_f32_16x16x32_bf16 v[48:51], v[148:151], v[16:19], 0
    v_mfma_f32_16x16x32_bf16 v[52:55], v[148:151], v[20:23], 0
    v_mfma_f32_16x16x32_bf16 v[56:59], v[148:151], v[24:27], 0
    v_mfma_f32_16x16x32_bf16 v[60:63], v[148:151], v[28:31], 0
    s_xor_b32 s60, s56, 20480
    buffer_load_dwordx4 v[148:151], v3, s[24:27], s60 offen nt
    v_add_f32 v68, v32, v37
    v_add_f32 v116, v42, v47
    v_add_f32 v68, v68, v116
    s_waitcnt vmcnt(31)
    v_mfma_f32_16x16x32_bf16 v[32:35], v[152:155], v[16:19], 0
    v_mfma_f32_16x16x32_bf16 v[36:39], v[152:155], v[20:23], 0
    v_mfma_f32_16x16x32_bf16 v[40:43], v[152:155], v[24:27], 0
    v_mfma_f32_16x16x32_bf16 v[44:47], v[152:155], v[28:31], 0
    s_xor_b32 s60, s56, 24576
    buffer_load_dwordx4 v[152:155], v3, s[24:27], s60 offen nt
    v_add_f32 v69, v48, v53
    v_add_f32 v116, v58, v63
    v_add_f32 v69, v69, v116
    s_waitcnt vmcnt(31)
    v_mfma_f32_16x16x32_bf16 v[48:51], v[156:159], v[16:19], 0
    v_mfma_f32_16x16x32_bf16 v[52:55], v[156:159], v[20:23], 0
    v_mfma_f32_16x16x32_bf16 v[56:59], v[156:159], v[24:27], 0
    v_mfma_f32_16x16x32_bf16 v[60:63], v[156:159], v[28:31], 0
    s_xor_b32 s60, s56, 28672
    buffer_load_dwordx4 v[156:159], v3, s[24:27], s60 offen nt
    v_add_f32 v70, v32, v37
    v_add_f32 v116, v42, v47
    v_add_f32 v70, v70, v116
    s_waitcnt vmcnt(31)
    v_mfma_f32_16x16x32_bf16 v[32:35], v[160:163], v[16:19], 0
    v_mfma_f32_16x16x32_bf16 v[36:39], v[160:163], v[20:23], 0
    v_mfma_f32_16x16x32_bf16 v[40:43], v[160:163], v[24:27], 0
    v_mfma_f32_16x16x32_bf16 v[44:47], v[160:163], v[28:31], 0
    s_xor_b32 s60, s56, 1024
    buffer_load_dwordx4 v[160:163], v3, s[24:27], s60 offen nt
    v_add_f32 v71, v48, v53
    v_add_f32 v116, v58, v63
    v_add_f32 v71, v71, v116
    s_waitcnt vmcnt(31)
    v_mfma_f32_16x16x32_bf16 v[48:51], v[164:167], v[16:19], 0
    v_mfma_f32_16x16x32_bf16 v[52:55], v[164:167], v[20:23], 0
    v_mfma_f32_16x16x32_bf16 v[56:59], v[164:167], v[24:27], 0
    v_mfma_f32_16x16x32_bf16 v[60:63], v[164:167], v[28:31], 0
    s_xor_b32 s60, s56, 5120
    buffer_load_dwordx4 v[164:167], v3, s[24:27], s60 offen nt
    v_add_f32 v72, v32, v37
    v_add_f32 v116, v42, v47
    v_add_f32 v72, v72, v116
    s_waitcnt vmcnt(31)
    v_mfma_f32_16x16x32_bf16 v[32:35], v[168:171], v[16:19], 0
    v_mfma_f32_16x16x32_bf16 v[36:39], v[168:171], v[20:23], 0
    v_mfma_f32_16x16x32_bf16 v[40:43], v[168:171], v[24:27], 0
    v_mfma_f32_16x16x32_bf16 v[44:47], v[168:171], v[28:31], 0
    s_xor_b32 s60, s56, 9216
    buffer_load_dwordx4 v[168:171], v3, s[24:27], s60 offen nt
    v_add_f32 v73, v48, v53
    v_add_f32 v116, v58, v63
    v_add_f32 v73, v73, v116
    s_waitcnt vmcnt(31)
    v_mfma_f32_16x16x32_bf16 v[48:51], v[172:175], v[16:19], 0
    v_mfma_f32_16x16x32_bf16 v[52:55], v[172:175], v[20:23], 0
    v_mfma_f32_16x16x32_bf16 v[56:59], v[172:175], v[24:27], 0
    v_mfma_f32_16x16x32_bf16 v[60:63], v[172:175], v[28:31], 0
    s_xor_b32 s60, s56, 13312
    buffer_load_dwordx4 v[172:175], v3, s[24:27], s60 offen nt
    v_add_f32 v74, v32, v37
    v_add_f32 v116, v42, v47
    v_add_f32 v74, v74, v116
    s_waitcnt vmcnt(31)
    v_mfma_f32_16x16x32_bf16 v[32:35], v[176:179], v[16:19], 0
    v_mfma_f32_16x16x32_bf16 v[36:39], v[176:179], v[20:23], 0
    v_mfma_f32_16x16x32_bf16 v[40:43], v[176:179], v[24:27], 0
    v_mfma_f32_16x16x32_bf16 v[44:47], v[176:179], v[28:31], 0
    s_xor_b32 s60, s56, 17408
    buffer_load_dwordx4 v[176:179], v3, s[24:27], s60 offen nt
    v_add_f32 v75, v48, v53
    v_add_f32 v116, v58, v63
    v_add_f32 v75, v75, v116
    s_waitcnt vmcnt(31)
    v_mfma_f32_16x16x32_bf16 v[48:51], v[180:183], v[16:19], 0
    v_mfma_f32_16x16x32_bf16 v[52:55], v[180:183], v[20:23], 0
    v_mfma_f32_16x16x32_bf16 v[56:59], v[180:183], v[24:27], 0
    v_mfma_f32_16x16x32_bf16 v[60:63], v[180:183], v[28:31], 0
    s_xor_b32 s60, s56, 21504
    buffer_load_dwordx4 v[180:183], v3, s[24:27], s60 offen nt
    v_add_f32 v76, v32, v37
    v_add_f32 v116, v42, v47
    v_add_f32 v76, v76, v116
    s_waitcnt vmcnt(31)
    v_mfma_f32_16x16x32_bf16 v[32:35], v[184:187], v[16:19], 0
    v_mfma_f32_16x16x32_bf16 v[36:39], v[184:187], v[20:23], 0
    v_mfma_f32_16x16x32_bf16 v[40:43], v[184:187], v[24:27], 0
    v_mfma_f32_16x16x32_bf16 v[44:47], v[184:187], v[28:31], 0
    s_xor_b32 s60, s56, 25600
    buffer_load_dwordx4 v[184:187], v3, s[24:27], s60 offen nt
    v_add_f32 v77, v48, v53
    v_add_f32 v116, v58, v63
    v_add_f32 v77, v77, v116
    s_waitcnt vmcnt(31)
    v_mfma_f32_16x16x32_bf16 v[48:51], v[188:191], v[16:19], 0
    v_mfma_f32_16x16x32_bf16 v[52:55], v[188:191], v[20:23], 0
    v_mfma_f32_16x16x32_bf16 v[56:59], v[188:191], v[24:27], 0
    v_mfma_f32_16x16x32_bf16 v[60:63], v[188:191], v[28:31], 0
    s_xor_b32 s60, s56, 29696
    buffer_load_dwordx4 v[188:191], v3, s[24:27], s60 offen nt
    v_add_f32 v78, v32, v37
    v_add_f32 v116, v42, v47
    v_add_f32 v78, v78, v116
    s_waitcnt vmcnt(31)
    v_mfma_f32_16x16x32_bf16 v[32:35], v[192:195], v[16:19], 0
    v_mfma_f32_16x16x32_bf16 v[36:39], v[192:195], v[20:23], 0
    v_mfma_f32_16x16x32_bf16 v[40:43], v[192:195], v[24:27], 0
    v_mfma_f32_16x16x32_bf16 v[44:47], v[192:195], v[28:31], 0
    s_xor_b32 s60, s56, 2048
    buffer_load_dwordx4 v[192:195], v3, s[24:27], s60 offen nt
    v_add_f32 v79, v48, v53
    v_add_f32 v116, v58, v63
    v_add_f32 v79, v79, v116
    s_waitcnt vmcnt(31)
    v_mfma_f32_16x16x32_bf16 v[48:51], v[196:199], v[16:19], 0
    v_mfma_f32_16x16x32_bf16 v[52:55], v[196:199], v[20:23], 0
    v_mfma_f32_16x16x32_bf16 v[56:59], v[196:199], v[24:27], 0
    v_mfma_f32_16x16x32_bf16 v[60:63], v[196:199], v[28:31], 0
    s_xor_b32 s60, s56, 6144
    buffer_load_dwordx4 v[196:199], v3, s[24:27], s60 offen nt
    v_add_f32 v80, v32, v37
    v_add_f32 v116, v42, v47
    v_add_f32 v80, v80, v116
    s_waitcnt vmcnt(31)
    v_mfma_f32_16x16x32_bf16 v[32:35], v[200:203], v[16:19], 0
    v_mfma_f32_16x16x32_bf16 v[36:39], v[200:203], v[20:23], 0
    v_mfma_f32_16x16x32_bf16 v[40:43], v[200:203], v[24:27], 0
    v_mfma_f32_16x16x32_bf16 v[44:47], v[200:203], v[28:31], 0
    s_xor_b32 s60, s56, 10240
    buffer_load_dwordx4 v[200:203], v3, s[24:27], s60 offen nt
    v_add_f32 v81, v48, v53
    v_add_f32 v116, v58, v63
    v_add_f32 v81, v81, v116
    s_waitcnt vmcnt(31)
    v_mfma_f32_16x16x32_bf16 v[48:51], v[204:207], v[16:19], 0
    v_mfma_f32_16x16x32_bf16 v[52:55], v[204:207], v[20:23], 0
    v_mfma_f32_16x16x32_bf16 v[56:59], v[204:207], v[24:27], 0
    v_mfma_f32_16x16x32_bf16 v[60:63], v[204:207], v[28:31], 0
    s_xor_b32 s60, s56, 14336
    buffer_load_dwordx4 v[204:207], v3, s[24:27], s60 offen nt
    v_add_f32 v82, v32, v37
    v_add_f32 v116, v42, v47
    v_add_f32 v82, v82, v116
    s_waitcnt vmcnt(31)
    v_mfma_f32_16x16x32_bf16 v[32:35], v[208:211], v[16:19], 0
    v_mfma_f32_16x16x32_bf16 v[36:39], v[208:211], v[20:23], 0
    v_mfma_f32_16x16x32_bf16 v[40:43], v[208:211], v[24:27], 0
    v_mfma_f32_16x16x32_bf16 v[44:47], v[208:211], v[28:31], 0
    s_xor_b32 s60, s56, 18432
    buffer_load_dwordx4 v[208:211], v3, s[24:27], s60 offen nt
    v_add_f32 v83, v48, v53
    v_add_f32 v116, v58, v63
    v_add_f32 v83, v83, v116
    s_waitcnt vmcnt(31)
    v_mfma_f32_16x16x32_bf16 v[48:51], v[212:215], v[16:19], 0
    v_mfma_f32_16x16x32_bf16 v[52:55], v[212:215], v[20:23], 0
    v_mfma_f32_16x16x32_bf16 v[56:59], v[212:215], v[24:27], 0
    v_mfma_f32_16x16x32_bf16 v[60:63], v[212:215], v[28:31], 0
    s_xor_b32 s60, s56, 22528
    buffer_load_dwordx4 v[212:215], v3, s[24:27], s60 offen nt
    v_add_f32 v84, v32, v37
    v_add_f32 v116, v42, v47
    v_add_f32 v84, v84, v116
    s_waitcnt vmcnt(31)
    v_mfma_f32_16x16x32_bf16 v[32:35], v[216:219], v[16:19], 0
    v_mfma_f32_16x16x32_bf16 v[36:39], v[216:219], v[20:23], 0
    v_mfma_f32_16x16x32_bf16 v[40:43], v[216:219], v[24:27], 0
    v_mfma_f32_16x16x32_bf16 v[44:47], v[216:219], v[28:31], 0
    s_xor_b32 s60, s56, 26624
    buffer_load_dwordx4 v[216:219], v3, s[24:27], s60 offen nt
    v_add_f32 v85, v48, v53
    v_add_f32 v116, v58, v63
    v_add_f32 v85, v85, v116
    s_waitcnt vmcnt(31)
    v_mfma_f32_16x16x32_bf16 v[48:51], v[220:223], v[16:19], 0
    v_mfma_f32_16x16x32_bf16 v[52:55], v[220:223], v[20:23], 0
    v_mfma_f32_16x16x32_bf16 v[56:59], v[220:223], v[24:27], 0
    v_mfma_f32_16x16x32_bf16 v[60:63], v[220:223], v[28:31], 0
    s_xor_b32 s60, s56, 30720
    buffer_load_dwordx4 v[220:223], v3, s[24:27], s60 offen nt
    v_add_f32 v86, v32, v37
    v_add_f32 v116, v42, v47
    v_add_f32 v86, v86, v116
    s_waitcnt vmcnt(31)
    v_mfma_f32_16x16x32_bf16 v[32:35], v[224:227], v[16:19], 0
    v_mfma_f32_16x16x32_bf16 v[36:39], v[224:227], v[20:23], 0
    v_mfma_f32_16x16x32_bf16 v[40:43], v[224:227], v[24:27], 0
    v_mfma_f32_16x16x32_bf16 v[44:47], v[224:227], v[28:31], 0
    s_xor_b32 s60, s56, 3072
    buffer_load_dwordx4 v[224:227], v3, s[24:27], s60 offen nt
    v_add_f32 v87, v48, v53
    v_add_f32 v116, v58, v63
    v_add_f32 v87, v87, v116
    s_waitcnt vmcnt(31)
    v_mfma_f32_16x16x32_bf16 v[48:51], v[228:231], v[16:19], 0
    v_mfma_f32_16x16x32_bf16 v[52:55], v[228:231], v[20:23], 0
    v_mfma_f32_16x16x32_bf16 v[56:59], v[228:231], v[24:27], 0
    v_mfma_f32_16x16x32_bf16 v[60:63], v[228:231], v[28:31], 0
    s_xor_b32 s60, s56, 7168
    buffer_load_dwordx4 v[228:231], v3, s[24:27], s60 offen nt
    v_add_f32 v88, v32, v37
    v_add_f32 v116, v42, v47
    v_add_f32 v88, v88, v116
    s_waitcnt vmcnt(31)
    v_mfma_f32_16x16x32_bf16 v[32:35], v[232:235], v[16:19], 0
    v_mfma_f32_16x16x32_bf16 v[36:39], v[232:235], v[20:23], 0
    v_mfma_f32_16x16x32_bf16 v[40:43], v[232:235], v[24:27], 0
    v_mfma_f32_16x16x32_bf16 v[44:47], v[232:235], v[28:31], 0
    s_xor_b32 s60, s56, 11264
    buffer_load_dwordx4 v[232:235], v3, s[24:27], s60 offen nt
    v_add_f32 v89, v48, v53
    v_add_f32 v116, v58, v63
    v_add_f32 v89, v89, v116
    s_waitcnt vmcnt(31)
    v_mfma_f32_16x16x32_bf16 v[48:51], v[236:239], v[16:19], 0
    v_mfma_f32_16x16x32_bf16 v[52:55], v[236:239], v[20:23], 0
    v_mfma_f32_16x16x32_bf16 v[56:59], v[236:239], v[24:27], 0
    v_mfma_f32_16x16x32_bf16 v[60:63], v[236:239], v[28:31], 0
    s_xor_b32 s60, s56, 15360
    buffer_load_dwordx4 v[236:239], v3, s[24:27], s60 offen nt
    v_add_f32 v90, v32, v37
    v_add_f32 v116, v42, v47
    v_add_f32 v90, v90, v116
    s_waitcnt vmcnt(31)
    v_mfma_f32_16x16x32_bf16 v[32:35], v[240:243], v[16:19], 0
    v_mfma_f32_16x16x32_bf16 v[36:39], v[240:243], v[20:23], 0
    v_mfma_f32_16x16x32_bf16 v[40:43], v[240:243], v[24:27], 0
    v_mfma_f32_16x16x32_bf16 v[44:47], v[240:243], v[28:31], 0
    s_xor_b32 s60, s56, 19456
    buffer_load_dwordx4 v[240:243], v3, s[24:27], s60 offen nt
    v_add_f32 v91, v48, v53
    v_add_f32 v116, v58, v63
    v_add_f32 v91, v91, v116
    s_waitcnt vmcnt(31)
    v_mfma_f32_16x16x32_bf16 v[48:51], v[244:247], v[16:19], 0
    v_mfma_f32_16x16x32_bf16 v[52:55], v[244:247], v[20:23], 0
    v_mfma_f32_16x16x32_bf16 v[56:59], v[244:247], v[24:27], 0
    v_mfma_f32_16x16x32_bf16 v[60:63], v[244:247], v[28:31], 0
    s_xor_b32 s60, s56, 23552
    buffer_load_dwordx4 v[244:247], v3, s[24:27], s60 offen nt
    v_add_f32 v92, v32, v37
    v_add_f32 v116, v42, v47
    v_add_f32 v92, v92, v116
    s_waitcnt vmcnt(31)
    v_mfma_f32_16x16x32_bf16 v[32:35], v[248:251], v[16:19], 0
    v_mfma_f32_16x16x32_bf16 v[36:39], v[248:251], v[20:23], 0
    v_mfma_f32_16x16x32_bf16 v[40:43], v[248:251], v[24:27], 0
    v_mfma_f32_16x16x32_bf16 v[44:47], v[248:251], v[28:31], 0
    s_xor_b32 s60, s56, 27648
    buffer_load_dwordx4 v[248:251], v3, s[24:27], s60 offen nt
    v_add_f32 v93, v48, v53
    v_add_f32 v116, v58, v63
    v_add_f32 v93, v93, v116
    s_waitcnt vmcnt(31)
    v_mfma_f32_16x16x32_bf16 v[48:51], v[252:255], v[16:19], 0
    v_mfma_f32_16x16x32_bf16 v[52:55], v[252:255], v[20:23], 0
    v_mfma_f32_16x16x32_bf16 v[56:59], v[252:255], v[24:27], 0
    v_mfma_f32_16x16x32_bf16 v[60:63], v[252:255], v[28:31], 0
    s_xor_b32 s60, s56, 31744
    buffer_load_dwordx4 v[252:255], v3, s[24:27], s60 offen nt
    v_add_f32 v94, v32, v37
    v_add_f32 v116, v42, v47
    v_add_f32 v94, v94, v116
    s_nop 7
    v_add_f32 v95, v48, v53
    v_add_f32 v116, v58, v63
    v_add_f32 v95, v95, v116
    s_cmp_lg_u32 s3, 6
    s_cbranch_scc1 L_nyt
    v_lshlrev_b32 v11, 5, v1
    s_lshl_b32 s59, s34, 16
    s_lshl_b32 s60, s54, 13
    s_add_u32 s59, s59, s60
    s_lshl_b32 s60, s35, 11
    s_add_u32 s59, s59, s60
    s_add_u32 s59, s59, 0x300000
    buffer_load_dword v125, v11, s[28:31], s59 offen sc1
L_nyt:
    v_lshrrev_b32 v10, 3, v1
    v_lshlrev_b32 v10, 10, v10
    v_and_b32 v11, 7, v1
    v_lshl_add_u32 v10, v11, 4, v10
    s_lshl_b32 s59, s33, 17
    s_lshl_b32 s60, s34, 7
    s_add_u32 s59, s59, s60
    s_lshl_b32 s60, s3, 14
    s_add_u32 s59, s59, s60
    s_lshl_b32 s60, s3, 11
    s_add_u32 m0, s60, 16384
    s_nop 0
    buffer_load_dwordx4 v10, s[48:51], s59 offen nt lds
    s_add_u32 m0, s60, 17408
    s_add_u32 s59, s59, 8192
    buffer_load_dwordx4 v10, s[48:51], s59 offen nt lds
    v_max3_f32 v117, v64, v65, v66
    v_max3_f32 v117, v117, v67, v68
    v_max3_f32 v117, v117, v69, v70
    v_max3_f32 v117, v117, v71, v72
    v_max3_f32 v117, v117, v73, v74
    v_max3_f32 v117, v117, v75, v76
    v_max3_f32 v117, v117, v77, v78
    v_max3_f32 v117, v117, v79, v80
    v_max3_f32 v117, v117, v81, v82
    v_max3_f32 v117, v117, v83, v84
    v_max3_f32 v117, v117, v85, v86
    v_max3_f32 v117, v117, v87, v88
    v_max3_f32 v117, v117, v89, v90
    v_max3_f32 v117, v117, v91, v92
    v_max3_f32 v117, v117, v93, v94
    v_max_f32 v117, v117, v95
    v_mov_b32 v119, v117
    s_nop 1
    v_permlane16_swap_b32 v119, v117
    s_nop 1
    v_max_f32 v117, v117, v119
    v_mov_b32 v119, v117
    s_nop 1
    v_permlane32_swap_b32 v119, v117
    s_nop 1
    v_max_f32 v117, v117, v119
    v_mul_f32 v117, s57, v117
    v_mov_b32 v118, 0
    v_fma_f32 v64, v64, s57, -v117
    v_fma_f32 v65, v65, s57, -v117
    v_fma_f32 v66, v66, s57, -v117
    v_fma_f32 v67, v67, s57, -v117
    v_fma_f32 v68, v68, s57, -v117
    v_fma_f32 v69, v69, s57, -v117
    v_fma_f32 v70, v70, s57, -v117
    v_fma_f32 v71, v71, s57, -v117
    v_fma_f32 v72, v72, s57, -v117
    v_fma_f32 v73, v73, s57, -v117
    v_fma_f32 v74, v74, s57, -v117
    v_fma_f32 v75, v75, s57, -v117
    v_fma_f32 v76, v76, s57, -v117
    v_fma_f32 v77, v77, s57, -v117
    v_fma_f32 v78, v78, s57, -v117
    v_fma_f32 v79, v79, s57, -v117
    v_fma_f32 v80, v80, s57, -v117
    v_fma_f32 v81, v81, s57, -v117
    v_fma_f32 v82, v82, s57, -v117
    v_fma_f32 v83, v83, s57, -v117
    v_fma_f32 v84, v84, s57, -v117
    v_fma_f32 v85, v85, s57, -v117
    v_fma_f32 v86, v86, s57, -v117
    v_fma_f32 v87, v87, s57, -v117
    v_fma_f32 v88, v88, s57, -v117
    v_fma_f32 v89, v89, s57, -v117
    v_fma_f32 v90, v90, s57, -v117
    v_fma_f32 v91, v91, s57, -v117
    v_fma_f32 v92, v92, s57, -v117
    v_fma_f32 v93, v93, s57, -v117
    v_fma_f32 v94, v94, s57, -v117
    v_fma_f32 v95, v95, s57, -v117
    v_exp_f32 v64, v64
    v_exp_f32 v65, v65
    v_exp_f32 v66, v66
    v_exp_f32 v67, v67
    v_exp_f32 v68, v68
    v_exp_f32 v69, v69
    v_exp_f32 v70, v70
    v_exp_f32 v71, v71
    v_exp_f32 v72, v72
    v_exp_f32 v73, v73
    v_exp_f32 v74, v74
    v_exp_f32 v75, v75
    v_exp_f32 v76, v76
    v_exp_f32 v77, v77
    v_exp_f32 v78, v78
    v_exp_f32 v79, v79
    v_exp_f32 v80, v80
    v_exp_f32 v81, v81
    v_exp_f32 v82, v82
    v_exp_f32 v83, v83
    v_exp_f32 v84, v84
    v_exp_f32 v85, v85
    v_exp_f32 v86, v86
    v_exp_f32 v87, v87
    v_exp_f32 v88, v88
    v_exp_f32 v89, v89
    v_exp_f32 v90, v90
    v_exp_f32 v91, v91
    v_exp_f32 v92, v92
    v_exp_f32 v93, v93
    v_exp_f32 v94, v94
    v_exp_f32 v95, v95
    v_add_f32 v118, v118, v64
    v_cvt_pk_bf16_f32 v64, v64, v64
    v_add_f32 v118, v118, v65
    v_cvt_pk_bf16_f32 v65, v65, v65
    v_add_f32 v118, v118, v66
    v_cvt_pk_bf16_f32 v66, v66, v66
    v_add_f32 v118, v118, v67
    v_cvt_pk_bf16_f32 v67, v67, v67
    v_add_f32 v118, v118, v68
    v_cvt_pk_bf16_f32 v68, v68, v68
    v_add_f32 v118, v118, v69
    v_cvt_pk_bf16_f32 v69, v69, v69
    v_add_f32 v118, v118, v70
    v_cvt_pk_bf16_f32 v70, v70, v70
    v_add_f32 v118, v118, v71
    v_cvt_pk_bf16_f32 v71, v71, v71
    v_add_f32 v118, v118, v72
    v_cvt_pk_bf16_f32 v72, v72, v72
    v_add_f32 v118, v118, v73
    v_cvt_pk_bf16_f32 v73, v73, v73
    v_add_f32 v118, v118, v74
    v_cvt_pk_bf16_f32 v74, v74, v74
    v_add_f32 v118, v118, v75
    v_cvt_pk_bf16_f32 v75, v75, v75
    v_add_f32 v118, v118, v76
    v_cvt_pk_bf16_f32 v76, v76, v76
    v_add_f32 v118, v118, v77
    v_cvt_pk_bf16_f32 v77, v77, v77
    v_add_f32 v118, v118, v78
    v_cvt_pk_bf16_f32 v78, v78, v78
    v_add_f32 v118, v118, v79
    v_cvt_pk_bf16_f32 v79, v79, v79
    v_add_f32 v118, v118, v80
    v_cvt_pk_bf16_f32 v80, v80, v80
    v_add_f32 v118, v118, v81
    v_cvt_pk_bf16_f32 v81, v81, v81
    v_add_f32 v118, v118, v82
    v_cvt_pk_bf16_f32 v82, v82, v82
    v_add_f32 v118, v118, v83
    v_cvt_pk_bf16_f32 v83, v83, v83
    v_add_f32 v118, v118, v84
    v_cvt_pk_bf16_f32 v84, v84, v84
    v_add_f32 v118, v118, v85
    v_cvt_pk_bf16_f32 v85, v85, v85
    v_add_f32 v118, v118, v86
    v_cvt_pk_bf16_f32 v86, v86, v86
    v_add_f32 v118, v118, v87
    v_cvt_pk_bf16_f32 v87, v87, v87
    v_add_f32 v118, v118, v88
    v_cvt_pk_bf16_f32 v88, v88, v88
    v_add_f32 v118, v118, v89
    v_cvt_pk_bf16_f32 v89, v89, v89
    v_add_f32 v118, v118, v90
    v_cvt_pk_bf16_f32 v90, v90, v90
    v_add_f32 v118, v118, v91
    v_cvt_pk_bf16_f32 v91, v91, v91
    v_add_f32 v118, v118, v92
    v_cvt_pk_bf16_f32 v92, v92, v92
    v_add_f32 v118, v118, v93
    v_cvt_pk_bf16_f32 v93, v93, v93
    v_add_f32 v118, v118, v94
    v_cvt_pk_bf16_f32 v94, v94, v94
    v_add_f32 v118, v118, v95
    v_cvt_pk_bf16_f32 v95, v95, v95
    v_mov_b32 v119, v118
    s_nop 1
    v_permlane16_swap_b32 v119, v118
    s_nop 1
    v_add_f32 v118, v118, v119
    v_mov_b32 v119, v118
    s_nop 1
    v_permlane32_swap_b32 v119, v118
    s_nop 1
    v_add_f32 v118, v118, v119
    v_lshlrev_b32 v10, 6, v8
    s_lshl_b32 s59, s3, 3
    s_add_u32 s59, s59, 36864
    v_add_u32 v10, s59, v10
    v_mov_b32 v122, v117
    v_mov_b32 v123, v118
    s_mov_b64 exec, 0x1111
    ds_write_b64 v10, v[122:123]
    s_mov_b64 exec, 1
    v_mov_b32 v11, 34820
    v_mov_b32 v12, 1
    ds_add_u32 v11, v12
    s_mov_b64 exec, -1
    v_lshlrev_b32 v10, 9, v7
    v_lshl_add_u32 v10, v6, 5, v10
    s_lshl_b32 s59, s3, 11
    s_add_u32 s59, s59, 0
    v_add_u32 v10, s59, v10
    v_and_b32 v98, v64, v4
    v_and_b32 v99, v64, v5
    v_and_b32 v102, v65, v4
    v_and_b32 v103, v65, v5
    s_waitcnt vmcnt(33)
    v_mfma_f32_16x16x32_bf16 v[108:111], v[98:101], v[128:131], 0
    v_mfma_f32_16x16x32_bf16 v[112:115], v[96:99], v[128:131], 0
    v_and_b32 v98, v66, v4
    v_and_b32 v99, v66, v5
    s_waitcnt vmcnt(32)
    v_mfma_f32_16x16x32_bf16 v[108:111], v[102:105], v[132:135], v[108:111]
    v_mfma_f32_16x16x32_bf16 v[112:115], v[100:103], v[132:135], v[112:115]
    v_and_b32 v102, v67, v4
    v_and_b32 v103, v67, v5
    s_waitcnt vmcnt(31)
    v_mfma_f32_16x16x32_bf16 v[108:111], v[98:101], v[136:139], v[108:111]
    v_mfma_f32_16x16x32_bf16 v[112:115], v[96:99], v[136:139], v[112:115]
    v_and_b32 v98, v68, v4
    v_and_b32 v99, v68, v5
    s_waitcnt vmcnt(30)
    v_mfma_f32_16x16x32_bf16 v[108:111], v[102:105], v[140:143], v[108:111]
    v_mfma_f32_16x16x32_bf16 v[112:115], v[100:103], v[140:143], v[112:115]
    v_and_b32 v102, v69, v4
    v_and_b32 v103, v69, v5
    s_waitcnt vmcnt(29)
    v_mfma_f32_16x16x32_bf16 v[108:111], v[98:101], v[144:147], v[108:111]
    v_mfma_f32_16x16x32_bf16 v[112:115], v[96:99], v[144:147], v[112:115]
    v_and_b32 v98, v70, v4
    v_and_b32 v99, v70, v5
    s_waitcnt vmcnt(28)
    v_mfma_f32_16x16x32_bf16 v[108:111], v[102:105], v[148:151], v[108:111]
    v_mfma_f32_16x16x32_bf16 v[112:115], v[100:103], v[148:151], v[112:115]
    v_and_b32 v102, v71, v4
    v_and_b32 v103, v71, v5
    s_waitcnt vmcnt(27)
    v_mfma_f32_16x16x32_bf16 v[108:111], v[98:101], v[152:155], v[108:111]
    v_mfma_f32_16x16x32_bf16 v[112:115], v[96:99], v[152:155], v[112:115]
    v_and_b32 v98, v72, v4
    v_and_b32 v99, v72, v5
    s_waitcnt vmcnt(26)
    v_mfma_f32_16x16x32_bf16 v[108:111], v[102:105], v[156:159], v[108:111]
    v_mfma_f32_16x16x32_bf16 v[112:115], v[100:103], v[156:159], v[112:115]
    v_and_b32 v102, v73, v4
    v_and_b32 v103, v73, v5
    s_waitcnt vmcnt(25)
    v_mfma_f32_16x16x32_bf16 v[108:111], v[98:101], v[160:163], v[108:111]
    v_mfma_f32_16x16x32_bf16 v[112:115], v[96:99], v[160:163], v[112:115]
    v_and_b32 v98, v74, v4
    v_and_b32 v99, v74, v5
    s_waitcnt vmcnt(24)
    v_mfma_f32_16x16x32_bf16 v[108:111], v[102:105], v[164:167], v[108:111]
    v_mfma_f32_16x16x32_bf16 v[112:115], v[100:103], v[164:167], v[112:115]
    v_and_b32 v102, v75, v4
    v_and_b32 v103, v75, v5
    s_waitcnt vmcnt(23)
    v_mfma_f32_16x16x32_bf16 v[108:111], v[98:101], v[168:171], v[108:111]
    v_mfma_f32_16x16x32_bf16 v[112:115], v[96:99], v[168:171], v[112:115]
    v_and_b32 v98, v76, v4
    v_and_b32 v99, v76, v5
    s_waitcnt vmcnt(22)
    v_mfma_f32_16x16x32_bf16 v[108:111], v[102:105], v[172:175], v[108:111]
    v_mfma_f32_16x16x32_bf16 v[112:115], v[100:103], v[172:175], v[112:115]
    v_and_b32 v102, v77, v4
    v_and_b32 v103, v77, v5
    s_waitcnt vmcnt(21)
    v_mfma_f32_16x16x32_bf16 v[108:111], v[98:101], v[176:179], v[108:111]
    v_mfma_f32_16x16x32_bf16 v[112:115], v[96:99], v[176:179], v[112:115]
    v_and_b32 v98, v78, v4
    v_and_b32 v99, v78, v5
    s_waitcnt vmcnt(20)
    v_mfma_f32_16x16x32_bf16 v[108:111], v[102:105], v[180:183], v[108:111]
    v_mfma_f32_16x16x32_bf16 v[112:115], v[100:103], v[180:183], v[112:115]
    v_and_b32 v102, v79, v4
    v_and_b32 v103, v79, v5
    s_waitcnt vmcnt(19)
    v_mfma_f32_16x16x32_bf16 v[108:111], v[98:101], v[184:187], v[108:111]
    v_mfma_f32_16x16x32_bf16 v[112:115], v[96:99], v[184:187], v[112:115]
    v_and_b32 v98, v80, v4
    v_and_b32 v99, v80, v5
    s_waitcnt vmcnt(18)
    v_mfma_f32_16x16x32_bf16 v[108:111], v[102:105], v[188:191], v[108:111]
    v_mfma_f32_16x16x32_bf16 v[112:115], v[100:103], v[188:191], v[112:115]
    v_and_b32 v102, v81, v4
    v_and_b32 v103, v81, v5
    s_waitcnt vmcnt(17)
    v_mfma_f32_16x16x32_bf16 v[108:111], v[98:101], v[192:195], v[108:111]
    v_mfma_f32_16x16x32_bf16 v[112:115], v[96:99], v[192:195], v[112:115]
    v_and_b32 v98, v82, v4
    v_and_b32 v99, v82, v5
    s_waitcnt vmcnt(16)
    v_mfma_f32_16x16x32_bf16 v[108:111], v[102:105], v[196:199], v[108:111]
    v_mfma_f32_16x16x32_bf16 v[112:115], v[100:103], v[196:199], v[112:115]
    v_and_b32 v102, v83, v4
    v_and_b32 v103, v83, v5
    s_waitcnt vmcnt(15)
    v_mfma_f32_16x16x32_bf16 v[108:111], v[98:101], v[200:203], v[108:111]
    v_mfma_f32_16x16x32_bf16 v[112:115], v[96:99], v[200:203], v[112:115]
    v_and_b32 v98, v84, v4
    v_and_b32 v99, v84, v5
    s_waitcnt vmcnt(14)
    v_mfma_f32_16x16x32_bf16 v[108:111], v[102:105], v[204:207], v[108:111]
    v_mfma_f32_16x16x32_bf16 v[112:115], v[100:103], v[204:207], v[112:115]
    v_and_b32 v102, v85, v4
    v_and_b32 v103, v85, v5
    s_waitcnt vmcnt(13)
    v_mfma_f32_16x16x32_bf16 v[108:111], v[98:101], v[208:211], v[108:111]
    v_mfma_f32_16x16x32_bf16 v[112:115], v[96:99], v[208:211], v[112:115]
    v_and_b32 v98, v86, v4
    v_and_b32 v99, v86, v5
    s_waitcnt vmcnt(12)
    v_mfma_f32_16x16x32_bf16 v[108:111], v[102:105], v[212:215], v[108:111]
    v_mfma_f32_16x16x32_bf16 v[112:115], v[100:103], v[212:215], v[112:115]
    v_and_b32 v102, v87, v4
    v_and_b32 v103, v87, v5
    s_waitcnt vmcnt(11)
    v_mfma_f32_16x16x32_bf16 v[108:111], v[98:101], v[216:219], v[108:111]
    v_mfma_f32_16x16x32_bf16 v[112:115], v[96:99], v[216:219], v[112:115]
    v_and_b32 v98, v88, v4
    v_and_b32 v99, v88, v5
    s_waitcnt vmcnt(10)
    v_mfma_f32_16x16x32_bf16 v[108:111], v[102:105], v[220:223], v[108:111]
    v_mfma_f32_16x16x32_bf16 v[112:115], v[100:103], v[220:223], v[112:115]
    v_and_b32 v102, v89, v4
    v_and_b32 v103, v89, v5
    s_waitcnt vmcnt(9)
    v_mfma_f32_16x16x32_bf16 v[108:111], v[98:101], v[224:227], v[108:111]
    v_mfma_f32_16x16x32_bf16 v[112:115], v[96:99], v[224:227], v[112:115]
    v_and_b32 v98, v90, v4
    v_and_b32 v99, v90, v5
    s_waitcnt vmcnt(8)
    v_mfma_f32_16x16x32_bf16 v[108:111], v[102:105], v[228:231], v[108:111]
    v_mfma_f32_16x16x32_bf16 v[112:115], v[100:103], v[228:231], v[112:115]
    v_and_b32 v102, v91, v4
    v_and_b32 v103, v91, v5
    s_waitcnt vmcnt(7)
    v_mfma_f32_16x16x32_bf16 v[108:111], v[98:101], v[232:235], v[108:111]
    v_mfma_f32_16x16x32_bf16 v[112:115], v[96:99], v[232:235], v[112:115]
    v_and_b32 v98, v92, v4
    v_and_b32 v99, v92, v5
    s_waitcnt vmcnt(6)
    v_mfma_f32_16x16x32_bf16 v[108:111], v[102:105], v[236:239], v[108:111]
    v_mfma_f32_16x16x32_bf16 v[112:115], v[100:103], v[236:239], v[112:115]
    v_and_b32 v102, v93, v4
    v_and_b32 v103, v93, v5
    s_waitcnt vmcnt(5)
    v_mfma_f32_16x16x32_bf16 v[108:111], v[98:101], v[240:243], v[108:111]
    v_mfma_f32_16x16x32_bf16 v[112:115], v[96:99], v[240:243], v[112:115]
    v_and_b32 v98, v94, v4
    v_and_b32 v99, v94, v5
    s_waitcnt vmcnt(4)
    v_mfma_f32_16x16x32_bf16 v[108:111], v[102:105], v[244:247], v[108:111]
    v_mfma_f32_16x16x32_bf16 v[112:115], v[100:103], v[244:247], v[112:115]
    v_and_b32 v102, v95, v4
    v_and_b32 v103, v95, v5
    s_waitcnt vmcnt(3)
    v_mfma_f32_16x16x32_bf16 v[108:111], v[98:101], v[248:251], v[108:111]
    v_mfma_f32_16x16x32_bf16 v[112:115], v[96:99], v[248:251], v[112:115]
    s_nop 1
    s_waitcnt vmcnt(2)
    v_mfma_f32_16x16x32_bf16 v[108:111], v[102:105], v[252:255], v[108:111]
    v_mfma_f32_16x16x32_bf16 v[112:115], v[100:103], v[252:255], v[112:115]
    s_nop 7
    ds_write_b128 v10, v[108:111]
    ds_write_b128 v10, v[112:115] offset:16
    v_mov_b32 v15, 0xffffff00
    v_mov_b32 v10, 34816
    v_mov_b32 v12, 1
    s_waitcnt vmcnt(0) lgkmcnt(0)
    s_mov_b64 exec, 1
    ds_add_u32 v10, v12 offset:16
    s_mov_b64 exec, -1
    s_cmp_ge_u32 s3, 2
    s_cbranch_scc1 L_notc
L_wml:
    ds_read_b32 v125, v10 offset:4
    ds_read_b32 v124, v10 offset:8
    s_waitcnt lgkmcnt(0)
    v_readfirstlane_b32 s58, v125
    v_readfirstlane_b32 s101, v124
    s_cmp_lg_u32 s58, 12
    s_cbranch_scc1 L_wml
    v_lshrrev_b32 v11, 5, v1
    v_and_b32 v12, 31, v1
    s_lshl_b32 s59, s3, 1
    v_add_u32 v13, s59, v11
    v_lshlrev_b32 v14, 6, v13
    v_add_u32 v14, 36864, v14
    ds_read_b128 v[128:131], v14 offset:0
    ds_read_b128 v[132:135], v14 offset:16
    ds_read_b128 v[136:139], v14 offset:32
    ds_read_b128 v[140:143], v14 offset:48
    v_lshlrev_b32 v14, 9, v13
    v_lshl_add_u32 v14, v12, 4, v14
    v_lshlrev_b32 v13, 14, v11
    v_lshl_add_u32 v13, v12, 4, v13
    v_lshlrev_b32 v11, 9, v11
    s_lshl_b32 s90, s54, 16
    s_lshl_b32 s60, s52, 11
    s_add_u32 s90, s90, s60
    s_lshl_b32 s60, s55, 9
    s_add_u32 s90, s90, s60
    s_lshl_b32 s60, s3, 15
    s_add_u32 s90, s90, s60
    s_add_u32 s90, s90, 0x200000
    s_lshl_b32 s58, s54, 11
    s_lshl_b32 s60, s52, 6
    s_add_u32 s58, s58, s60
    s_lshl_b32 s60, s55, 4
    s_add_u32 s58, s58, s60
    s_lshl_b32 s60, s3, 10
    s_add_u32 s58, s58, s60
    s_add_u32 s58, s58, 0x280000
    s_waitcnt lgkmcnt(0)
    v_max3_f32 v116, v128, v130, v132
    v_max3_f32 v116, v116, v134, v136
    v_max3_f32 v116, v116, v138, v140
    v_max_f32 v116, v116, v142
    v_and_b32 v116, v116, v15
    v_sub_f32 v128, v128, v116
    v_sub_f32 v130, v130, v116
    v_sub_f32 v132, v132, v116
    v_sub_f32 v134, v134, v116
    v_sub_f32 v136, v136, v116
    v_sub_f32 v138, v138, v116
    v_sub_f32 v140, v140, v116
    v_sub_f32 v142, v142, v116
    v_exp_f32 v128, v128
    v_exp_f32 v130, v130
    v_exp_f32 v132, v132
    v_exp_f32 v134, v134
    v_exp_f32 v136, v136
    v_exp_f32 v138, v138
    v_exp_f32 v140, v140
    v_exp_f32 v142, v142
    s_nop 0
    v_mul_f32 v118, v128, v129
    v_fmac_f32 v118, v130, v131
    v_fmac_f32 v118, v132, v133
    v_fmac_f32 v118, v134, v135
    v_fmac_f32 v118, v136, v137
    v_fmac_f32 v118, v138, v139
    v_fmac_f32 v118, v140, v141
    v_fmac_f32 v118, v142, v143
    s_and_b32 s59, s97, 0xff
    v_or_b32 v116, s59, v116
    v_and_or_b32 v118, v118, v15, s59
    v_mov_b32 v117, s98
    v_mov_b32 v119, s98
    s_mov_b32 exec_lo, 1
    s_mov_b32 exec_hi, 1
    s_cmp_eq_u32 s101, 1
    s_cbranch_scc0 L_mlr
    buffer_store_dwordx4 v[116:119], v11, s[28:31], s58 offen
    s_branch L_mld
L_mlr:
    buffer_store_dwordx4 v[116:119], v11, s[28:31], s58 offen sc1
L_mld:
    s_mov_b64 exec, -1
    v_lshlrev_b32 v11, 3, v7
    v_add_u32 v11, v11, v8
    v_lshlrev_b32 v11, 7, v11
    v_lshl_add_u32 v11, v9, 3, v11
    s_lshl_b32 s59, s3, 6
    v_add_u32 v11, s59, v11
    v_and_b32 v127, 7, v6
    v_mul_u32_u24 v126, 272, v127
    v_lshl_add_u32 v126, v7, 4, v126
    v_lshlrev_b32 v127, 13, v127
    v_lshl_add_u32 v127, v7, 4, v127
    s_lshl_b32 s89, s34, 16
    s_lshl_b32 s60, s33, 6
    s_add_u32 s89, s89, s60
    s_lshl_b32 s60, s3, 12
    s_add_u32 s89, s89, s60
    s_add_u32 s89, s89, 0x300000
L_wo8:
    ds_read_b32 v125, v10 offset:16
    s_waitcnt lgkmcnt(0)
    v_readfirstlane_b32 s58, v125
    s_nop 0
    s_cmp_lg_u32 s58, 8
    s_cbranch_scc1 L_wo8
    ds_read_b128 v[144:147], v14 offset:0
    ds_read_b128 v[148:151], v14 offset:2048
    ds_read_b128 v[152:155], v14 offset:4096
    ds_read_b128 v[156:159], v14 offset:6144
    ds_read_b128 v[160:163], v14 offset:8192
    ds_read_b128 v[164:167], v14 offset:10240
    ds_read_b128 v[168:171], v14 offset:12288
    ds_read_b128 v[172:175], v14 offset:14336
    s_waitcnt lgkmcnt(7)
    v_mul_f32 v120, v128, v144
    v_mul_f32 v121, v128, v145
    v_mul_f32 v122, v128, v146
    v_mul_f32 v123, v128, v147
    s_waitcnt lgkmcnt(6)
    v_fmac_f32 v120, v130, v148
    v_fmac_f32 v121, v130, v149
    v_fmac_f32 v122, v130, v150
    v_fmac_f32 v123, v130, v151
    s_waitcnt lgkmcnt(5)
    v_fmac_f32 v120, v132, v152
    v_fmac_f32 v121, v132, v153
    v_fmac_f32 v122, v132, v154
    v_fmac_f32 v123, v132, v155
    s_waitcnt lgkmcnt(4)
    v_fmac_f32 v120, v134, v156
    v_fmac_f32 v121, v134, v157
    v_fmac_f32 v122, v134, v158
    v_fmac_f32 v123, v134, v159
    s_waitcnt lgkmcnt(3)
    v_fmac_f32 v120, v136, v160
    v_fmac_f32 v121, v136, v161
    v_fmac_f32 v122, v136, v162
    v_fmac_f32 v123, v136, v163
    s_waitcnt lgkmcnt(2)
    v_fmac_f32 v120, v138, v164
    v_fmac_f32 v121, v138, v165
    v_fmac_f32 v122, v138, v166
    v_fmac_f32 v123, v138, v167
    s_waitcnt lgkmcnt(1)
    v_fmac_f32 v120, v140, v168
    v_fmac_f32 v121, v140, v169
    v_fmac_f32 v122, v140, v170
    v_fmac_f32 v123, v140, v171
    s_waitcnt lgkmcnt(0)
    v_fmac_f32 v120, v142, v172
    v_fmac_f32 v121, v142, v173
    v_fmac_f32 v122, v142, v174
    v_fmac_f32 v123, v142, v175
    v_and_or_b32 v120, v120, v15, s99
    v_and_or_b32 v121, v121, v15, s99
    v_and_or_b32 v122, v122, v15, s99
    v_and_or_b32 v123, v123, v15, s99
    s_cmp_eq_u32 s101, 1
    s_cbranch_scc0 L_pubr
    buffer_store_dwordx4 v[120:123], v13, s[28:31], s90 offen
    s_branch L_pubd
L_pubr:
    buffer_store_dwordx4 v[120:123], v13, s[28:31], s90 offen sc1
L_pubd:
    ds_read_b64_tr_b16 v[176:177], v11 offset:16384
    ds_read_b64_tr_b16 v[178:179], v11 offset:16896
    ds_read_b64_tr_b16 v[180:181], v11 offset:20480
    ds_read_b64_tr_b16 v[182:183], v11 offset:20992
    ds_read_b64_tr_b16 v[184:185], v11 offset:24576
    ds_read_b64_tr_b16 v[186:187], v11 offset:25088
    ds_read_b64_tr_b16 v[188:189], v11 offset:28672
    ds_read_b64_tr_b16 v[190:191], v11 offset:29184
    ds_read_b64_tr_b16 v[192:193], v11 offset:16416
    ds_read_b64_tr_b16 v[194:195], v11 offset:16928
    ds_read_b64_tr_b16 v[196:197], v11 offset:20512
    ds_read_b64_tr_b16 v[198:199], v11 offset:21024
    ds_read_b64_tr_b16 v[200:201], v11 offset:24608
    ds_read_b64_tr_b16 v[202:203], v11 offset:25120
    ds_read_b64_tr_b16 v[204:205], v11 offset:28704
    ds_read_b64_tr_b16 v[206:207], v11 offset:29216
L_wc4:
    ds_read_b32 v125, v10 offset:20
    s_waitcnt lgkmcnt(0)
    v_readfirstlane_b32 s58, v125
    s_nop 0
    s_cmp_lg_u32 s58, 4
    s_cbranch_scc1 L_wc4
    ds_read_b128 v[208:211], v126 offset:37120
    ds_read_b128 v[212:215], v126 offset:37184
    ds_read_b128 v[216:219], v126 offset:37248
    ds_read_b128 v[220:223], v126 offset:37312
    s_waitcnt lgkmcnt(3)
    v_mfma_f32_16x16x32_bf16 v[32:35], v[176:179], v[208:211], 0
    v_mfma_f32_16x16x32_bf16 v[36:39], v[192:195], v[208:211], 0
    s_waitcnt lgkmcnt(2)
    v_mfma_f32_16x16x32_bf16 v[32:35], v[180:183], v[212:215], v[32:35]
    v_mfma_f32_16x16x32_bf16 v[36:39], v[196:199], v[212:215], v[36:39]
    s_waitcnt lgkmcnt(1)
    v_mfma_f32_16x16x32_bf16 v[32:35], v[184:187], v[216:219], v[32:35]
    v_mfma_f32_16x16x32_bf16 v[36:39], v[200:203], v[216:219], v[36:39]
    s_waitcnt lgkmcnt(0)
    v_mfma_f32_16x16x32_bf16 v[32:35], v[188:191], v[220:223], v[32:35]
    v_mfma_f32_16x16x32_bf16 v[36:39], v[204:207], v[220:223], v[36:39]
    s_mov_b32 exec_lo, 0x00ff00ff
    s_mov_b32 exec_hi, 0x00ff00ff
    s_nop 4
    v_and_or_b32 v40, v32, v15, s99
    v_and_or_b32 v41, v33, v15, s99
    v_and_or_b32 v42, v34, v15, s99
    v_and_or_b32 v43, v35, v15, s99
    buffer_store_dwordx4 v[40:43], v127, s[28:31], s89 offen sc1
    v_and_or_b32 v44, v36, v15, s99
    v_and_or_b32 v45, v37, v15, s99
    v_and_or_b32 v46, v38, v15, s99
    v_and_or_b32 v47, v39, v15, s99
    buffer_store_dwordx4 v[44:47], v127, s[28:31], s89 offen offset:2048 sc1
    s_mov_b64 exec, -1
    s_branch L_fin
L_notc:
    s_cmp_eq_u32 s3, 6
    s_cbranch_scc1 L_reduce
    s_cmp_eq_u32 s3, 7
    s_cbranch_scc1 L_fin
    s_sub_u32 s89, s3, 2
    v_lshrrev_b32 v11, 5, v1
    v_and_b32 v14, 31, v1
    v_lshlrev_b32 v12, 11, v11
    v_lshl_add_u32 v12, v14, 4, v12
    v_lshlrev_b32 v13, 6, v11
    s_lshl_b32 s58, s33, 3
    s_lshl_b32 s60, s89, 1
    s_add_u32 s58, s58, s60
    s_lshl_b32 s59, s58, 11
    s_add_u32 s59, s59, 2097152
    s_lshl_b32 s60, s58, 6
    s_add_u32 s60, s60, 2621440
    v_mul_u32_u24 v125, 272, v11
    v_lshl_add_u32 v125, v14, 3, v125
    s_mul_i32 s58, s89, 544
    s_add_u32 s58, s58, 37120
    v_add_u32 v125, s58, v125
    s_mov_b32 s61, 20000
    s_and_b32 s88, s97, 0xff
L_wcs:
    ds_read_b32 v11, v10 offset:16
    s_waitcnt lgkmcnt(0)
    v_readfirstlane_b32 s58, v11
    s_nop 0
    s_cmp_lt_u32 s58, 8
    s_cbranch_scc1 L_wcs
L_poll0_loop:
    buffer_load_dwordx4 v[176:179], v13, s[28:31], s60 offen offset:0 sc1
    buffer_load_dwordx4 v[180:183], v13, s[28:31], s60 offen offset:16 sc1
    buffer_load_dwordx4 v[184:187], v13, s[28:31], s60 offen offset:32 sc1
    buffer_load_dwordx4 v[188:191], v13, s[28:31], s60 offen offset:48 sc1
    buffer_load_dwordx4 v[192:195], v12, s[28:31], s59 offen offset:0 sc1
    buffer_load_dwordx4 v[196:199], v12, s[28:31], s59 offen offset:512 sc1
    buffer_load_dwordx4 v[200:203], v12, s[28:31], s59 offen offset:1024 sc1
    buffer_load_dwordx4 v[204:207], v12, s[28:31], s59 offen offset:1536 sc1
    s_waitcnt vmcnt(4)
    v_xor_b32 v14, s88, v176
    v_xor_b32 v11, s88, v178
    v_or_b32 v14, v14, v11
    v_xor_b32 v11, s88, v180
    v_or_b32 v14, v14, v11
    v_xor_b32 v11, s88, v182
    v_or_b32 v14, v14, v11
    v_xor_b32 v11, s88, v184
    v_or_b32 v14, v14, v11
    v_xor_b32 v11, s88, v186
    v_or_b32 v14, v14, v11
    v_xor_b32 v11, s88, v188
    v_or_b32 v14, v14, v11
    v_xor_b32 v11, s88, v190
    v_or_b32 v14, v14, v11
    v_and_b32 v14, 0xff, v14
    v_xor_b32 v11, s98, v177
    v_or_b32 v14, v14, v11
    v_xor_b32 v11, s98, v179
    v_or_b32 v14, v14, v11
    v_xor_b32 v11, s98, v181
    v_or_b32 v14, v14, v11
    v_xor_b32 v11, s98, v183
    v_or_b32 v14, v14, v11
    v_xor_b32 v11, s98, v185
    v_or_b32 v14, v14, v11
    v_xor_b32 v11, s98, v187
    v_or_b32 v14, v14, v11
    v_xor_b32 v11, s98, v189
    v_or_b32 v14, v14, v11
    v_xor_b32 v11, s98, v191
    v_or_b32 v14, v14, v11
    v_cmp_ne_u32 vcc, 0, v14
    s_nop 1
    s_cbranch_vccz L_poll0_done
    s_waitcnt vmcnt(0)
    s_sleep 1
    s_sub_u32 s61, s61, 1
    s_cmp_lg_u32 s61, 0
    s_cbranch_scc1 L_poll0_loop
L_poll0_done:
    s_mov_b32 s61, 20000
    v_and_b32 v176, v176, v15
    v_and_b32 v180, v180, v15
    v_and_b32 v184, v184, v15
    v_and_b32 v188, v188, v15
    v_max3_f32 v116, v176, v180, v184
    v_max_f32 v116, v116, v188
    v_sub_f32 v176, v176, v116
    v_sub_f32 v180, v180, v116
    v_sub_f32 v184, v184, v116
    v_sub_f32 v188, v188, v116
    v_exp_f32 v176, v176
    v_exp_f32 v180, v180
    v_exp_f32 v184, v184
    v_exp_f32 v188, v188
    s_nop 0
    v_mul_f32 v117, v176, v178
    v_fmac_f32 v117, v180, v182
    v_fmac_f32 v117, v184, v186
    v_fmac_f32 v117, v188, v190
    v_rcp_f32 v117, v117
    s_nop 0
    v_mul_f32 v176, v176, v117
    v_mul_f32 v180, v180, v117
    v_mul_f32 v184, v184, v117
    v_mul_f32 v188, v188, v117
    s_branch L_poll1_chk
L_poll1_loop:
    buffer_load_dwordx4 v[192:195], v12, s[28:31], s59 offen offset:0 sc1
    buffer_load_dwordx4 v[196:199], v12, s[28:31], s59 offen offset:512 sc1
    buffer_load_dwordx4 v[200:203], v12, s[28:31], s59 offen offset:1024 sc1
    buffer_load_dwordx4 v[204:207], v12, s[28:31], s59 offen offset:1536 sc1
L_poll1_chk:
    s_waitcnt vmcnt(0)
    v_or3_b32 v14, v192, v193, v194
    v_and_b32 v11, v192, v193
    v_and_b32 v116, v194, v195
    v_or3_b32 v14, v14, v195, v196
    v_and_b32 v11, v11, v196
    v_and_b32 v116, v116, v197
    v_or3_b32 v14, v14, v197, v198
    v_and_b32 v11, v11, v198
    v_and_b32 v116, v116, v199
    v_or3_b32 v14, v14, v199, v200
    v_and_b32 v11, v11, v200
    v_and_b32 v116, v116, v201
    v_or3_b32 v14, v14, v201, v202
    v_and_b32 v11, v11, v202
    v_and_b32 v116, v116, v203
    v_or3_b32 v14, v14, v203, v204
    v_and_b32 v11, v11, v204
    v_and_b32 v116, v116, v205
    v_or3_b32 v14, v14, v205, v206
    v_and_b32 v11, v11, v206
    v_and_b32 v116, v116, v207
    v_or_b32 v14, v14, v207
    v_and_b32 v11, v11, v116
    v_xor_b32 v14, s99, v14
    v_xor_b32 v11, s99, v11
    v_or_b32 v14, v14, v11
    v_and_b32 v14, 0xff, v14
    v_cmp_ne_u32 vcc, 0, v14
    v_mul_f32 v120, v176, v192
    v_mul_f32 v121, v176, v193
    v_mul_f32 v122, v176, v194
    v_mul_f32 v123, v176, v195
    s_cbranch_vccz L_poll1_done
    s_sleep 1
    s_sub_u32 s61, s61, 1
    s_cmp_lg_u32 s61, 0
    s_cbranch_scc1 L_poll1_loop
L_poll1_done:
    v_fmac_f32 v120, v180, v196
    v_fmac_f32 v121, v180, v197
    v_fmac_f32 v122, v180, v198
    v_fmac_f32 v123, v180, v199
    v_fmac_f32 v120, v184, v200
    v_fmac_f32 v121, v184, v201
    v_fmac_f32 v122, v184, v202
    v_fmac_f32 v123, v184, v203
    v_fmac_f32 v120, v188, v204
    v_fmac_f32 v121, v188, v205
    v_fmac_f32 v122, v188, v206
    v_fmac_f32 v123, v188, v207
    v_cvt_pk_bf16_f32 v118, v120, v121
    v_cvt_pk_bf16_f32 v119, v122, v123
    ds_write_b64 v125, v[118:119]
    v_mov_b32 v12, 1
    s_mov_b64 exec, 1
    ds_add_u32 v10, v12 offset:20
    s_mov_b64 exec, -1
    s_branch L_fin
L_reduce:
    s_lshl_b32 s59, s34, 16
    s_lshl_b32 s60, s54, 13
    s_add_u32 s59, s59, s60
    s_lshl_b32 s60, s35, 11
    s_add_u32 s59, s59, s60
    s_add_u32 s59, s59, 0x300000
    s_mov_b32 s61, 20000
    v_lshlrev_b32 v13, 3, v1
    s_lshl_b32 s58, s54, 10
    s_lshl_b32 s60, s34, 7
    s_add_u32 s58, s58, s60
    s_lshl_b32 s60, s35, 5
    s_add_u32 s58, s58, s60
L_wrs:
    ds_read_b32 v11, v10 offset:20
    s_waitcnt lgkmcnt(0)
    v_readfirstlane_b32 s60, v11
    s_nop 0
    s_cmp_lt_u32 s60, 4
    s_cbranch_scc1 L_wrs
L_poll2_loop:
    buffer_load_dwordx4 v[128:131], v3, s[28:31], s59 offen offset:0 sc1
    buffer_load_dwordx4 v[132:135], v3, s[28:31], s59 offen offset:1024 sc1
    s_waitcnt vmcnt(0)
    v_or3_b32 v14, v128, v129, v130
    v_or3_b32 v14, v14, v131, v132
    v_or3_b32 v14, v14, v133, v134
    v_and_b32 v11, v128, v129
    v_and_b32 v10, v130, v131
    v_and_b32 v11, v11, v132
    v_and_b32 v10, v10, v133
    v_and_b32 v11, v11, v134
    v_and_b32 v10, v10, v135
    v_or_b32 v14, v14, v135
    v_and_b32 v11, v11, v10
    v_xor_b32 v14, s99, v14
    v_xor_b32 v11, s99, v11
    v_or_b32 v14, v14, v11
    v_and_b32 v14, 0xff, v14
    v_cmp_ne_u32 vcc, 0, v14
    v_add_f32 v144, v128, v132
    v_add_f32 v145, v129, v133
    v_add_f32 v146, v130, v134
    v_add_f32 v147, v131, v135
    s_cbranch_vccz L_poll2_done
    s_sleep 1
    s_sub_u32 s61, s61, 1
    s_cmp_lg_u32 s61, 0
    s_cbranch_scc1 L_poll2_loop
L_poll2_done:
    v_add_f32_dpp v144, v144, v144 row_ror:8 row_mask:0xf bank_mask:0xf
    v_add_f32_dpp v145, v145, v145 row_ror:8 row_mask:0xf bank_mask:0xf
    v_add_f32_dpp v146, v146, v146 row_ror:8 row_mask:0xf bank_mask:0xf
    v_add_f32_dpp v147, v147, v147 row_ror:8 row_mask:0xf bank_mask:0xf
    v_add_f32_dpp v144, v144, v144 row_ror:4 row_mask:0xf bank_mask:0xf
    v_add_f32_dpp v145, v145, v145 row_ror:4 row_mask:0xf bank_mask:0xf
    v_add_f32_dpp v146, v146, v146 row_ror:4 row_mask:0xf bank_mask:0xf
    v_add_f32_dpp v147, v147, v147 row_ror:4 row_mask:0xf bank_mask:0xf
    v_mov_b32 v148, v144
    v_mov_b32 v149, v145
    v_mov_b32 v150, v146
    v_mov_b32 v151, v147
    s_nop 0
    v_permlane16_swap_b32 v148, v144
    v_permlane16_swap_b32 v149, v145
    v_permlane16_swap_b32 v150, v146
    v_permlane16_swap_b32 v151, v147
    v_add_f32 v144, v144, v148
    v_add_f32 v145, v145, v149
    v_add_f32 v146, v146, v150
    v_add_f32 v147, v147, v151
    v_mov_b32 v148, v144
    v_mov_b32 v149, v145
    v_mov_b32 v150, v146
    v_mov_b32 v151, v147
    s_nop 0
    v_permlane32_swap_b32 v148, v144
    v_permlane32_swap_b32 v149, v145
    v_permlane32_swap_b32 v150, v146
    v_permlane32_swap_b32 v151, v147
    v_add_f32 v144, v144, v148
    v_add_f32 v145, v145, v149
    v_add_f32 v146, v146, v150
    v_add_f32 v147, v147, v151
    v_cvt_pk_bf16_f32 v152, v144, v145
    v_cvt_pk_bf16_f32 v153, v146, v147
    s_mov_b64 exec, 0xf
    buffer_store_dwordx2 v[152:153], v13, s[36:39], s58 offen
    s_cmp_lg_u32 s2, 0
    s_cbranch_scc1 L_noep
    v_mov_b32 v14, s98
    v_mov_b32 v13, 4198400
    s_mov_b64 exec, 1
    buffer_store_dword v14, v13, s[28:31], 0 offen sc1
L_noep:
    s_mov_b64 exec, -1
L_fin:
L_end:
    s_endpgm
.section .rodata,"a"
.p2align 6
.amdhsa_kernel standalone__gqa_block_cached__decode_kernel
  .amdhsa_next_free_vgpr 256
  .amdhsa_next_free_sgpr 102
  .amdhsa_accum_offset 256
  .amdhsa_group_segment_fixed_size 0
  .amdhsa_kernarg_size 64
  .amdhsa_user_sgpr_count 2
  .amdhsa_user_sgpr_kernarg_segment_ptr 1
  .amdhsa_system_sgpr_workgroup_id_x 1
.end_amdhsa_kernel
```
